```python
import torch

def _softmax(x, axis=-1):
    return torch.softmax(x, dim=axis)
def _gelu(x):
    return torch.nn.functional.gelu(x, approximate="tanh")
def _silu(x):
    return torch.nn.functional.silu(x)
def _sigmoid(x):
    return torch.sigmoid(x)
def _layernorm(x, axis=-1, eps=1e-5):
    m = x.mean(dim=axis, keepdim=True)
    v = x.var(dim=axis, keepdim=True, unbiased=False)
    return (x - m) / torch.sqrt(v + eps)
def _scatter_add(tgt, idx, src, axis=0):
    return tgt.clone().index_add_(axis, idx, src)
def _segment_sum(src, seg, n):
    out = torch.zeros((n,) + src.shape[1:], dtype=src.dtype)
    return out.index_add_(0, seg, src)
def _pad(x, pw):
    flat = tuple(v for pair in reversed(pw) for v in pair)
    return torch.nn.functional.pad(x, flat)

kernel_name = 'gated_mix__spectral_gfnet__dense_activation_gelu__prompt'

def setup_inputs():

    _w = (lambda a: (lambda t: t.to(torch.bfloat16) if t.is_floating_point() else t)(torch.as_tensor(a)))
    def _A_setup():
        B, S, D = 1, 2048, 448
        Df = D // 2 + 1
        return {
            "x": _w((lambda *s: torch.randn(*s, dtype=torch.bfloat16) * 0.05)(B, S, D)),
            "w_r": _w((lambda *s: torch.randn(*s, dtype=torch.bfloat16) * 0.8)(S, Df) * 0.02),
            "w_i": _w((lambda *s: torch.randn(*s, dtype=torch.bfloat16) * 0.8)(S, Df) * 0.02),
        }
    _A_in = _A_setup()

    def _B_setup():
        B, S, D, F = 1, 2048, 448, 1792
        return {
            "x": _w((lambda *s: torch.randn(*s, dtype=torch.bfloat16) * 0.05)(B, S, D)),
            "w1": _w((lambda *s: torch.randn(*s, dtype=torch.bfloat16) * 3.2)(D, F) * (D ** -0.5)),
            "b1": _w((lambda *s: torch.randn(*s, dtype=torch.bfloat16) * 3.2)(F) * 0.01),
            "w2": _w((lambda *s: torch.randn(*s, dtype=torch.bfloat16) * 0.05)(F, D) * (F ** -0.5)),
            "b2": _w((lambda *s: torch.randn(*s, dtype=torch.bfloat16) * 0.1)(D) * 0.01),
        }
    _B_in = _B_setup()

    return {
        "A_x": _A_in["x"],
        "A_w_r": _A_in["w_r"],
        "A_w_i": _A_in["w_i"],
        "B_x": _B_in["x"],
        "B_w1": _B_in["w1"],
        "B_b1": _B_in["b1"],
        "B_w2": _B_in["w2"],
        "B_b2": _B_in["b2"],
        "gate_w": _w((lambda *s: torch.randn(*s, dtype=torch.bfloat16) * 0.05)(448) * 16.0),
    }

def reference(A_x, A_w_r, A_w_i, B_x, B_w1, B_b1, B_w2, B_b2, gate_w):
    def _A_ref(x, w_r, w_i):
        B, S, D = x.shape
        X = (lambda x, axes=(-2,-1): torch.fft.rfft2(x.float(), dim=axes))(x, axes=(-2, -1))
        W = w_r + 1j * w_i
        X = X * W
        y = (lambda x, s, axes=(-2,-1): torch.fft.irfft2(x, s=s, dim=axes).to(torch.bfloat16))(X, (S, D), axes=(-2, -1))
        return y

    def _B_ref(x, w1, b1, w2, b2):
        h = torch.einsum("bsd,df->bsf", x, w1) + b1
        h = _gelu(h)
        return torch.einsum("bsf,fd->bsd", h, w2) + b2

    x = A_x
    g = _sigmoid((x * gate_w).sum(-1, keepdims=True))
    a = _A_ref(x, A_w_r, A_w_i)
    b = _B_ref(x, B_w1, B_b1, B_w2, B_b2)
    return g * a + (1 - g) * b
```

```asm
; @launch grid=(256,1,1) block=(512,1,1) lds=163840
.amdgcn_target "amdgcn-amd-amdhsa--gfx950"
.text
.globl gated_mix__spectral_gfnet__dense_activation_gelu__prompt_kernel
.p2align 8
.type gated_mix__spectral_gfnet__dense_activation_gelu__prompt_kernel,@function
gated_mix__spectral_gfnet__dense_activation_gelu__prompt_kernel:
    s_cmp_ge_u32 s2, 256
    s_cbranch_scc1 L_end
    s_load_dwordx16 s[48:63], s[0:1], 0
    s_load_dwordx8 s[64:71], s[0:1], 64
    v_lshrrev_b32 v2, 6, v0
    v_and_b32 v1, 63, v0
    v_readfirstlane_b32 s79, v2
    s_cmp_ge_u32 s2, 224
    s_cbranch_scc1 L_aux
    s_getpc_b64 s[96:97]
L_pc:
    s_lshr_b32 s78, s2, 3
    s_mul_i32 s78, s78, 12
    v_min_u32 v2, 11, v0
    v_add_u32 v2, s78, v2
    v_lshlrev_b32 v2, 7, v2
    v_min_u32 v2, L_end-L_pc, v2
    v_mov_b32 v3, s97
    v_add_co_u32 v2, vcc, s96, v2
    s_nop 1
    v_addc_co_u32 v3, vcc, 0, v3, vcc
    global_load_dword v143, v[2:3], off
    s_and_b32 s77, s2, 7
    s_lshr_b32 s78, s2, 3
    s_and_b32 s46, s77, 1
    s_lshr_b32 s77, s77, 1
    s_lshl_b32 s77, s77, 2
    s_and_b32 s44, s78, 3
    s_add_u32 s44, s44, s77
    s_lshr_b32 s47, s78, 2
    s_mul_i32 s45, s46, 7
    s_add_u32 s45, s45, s47
    s_and_b32 s72, s79, 3
    s_and_b32 s77, s78, 3
    s_lshl_b32 s77, s77, 1
    s_add_u32 s77, s77, s47
    s_sub_u32 s78, s77, 7
    s_cmp_ge_u32 s77, 7
    s_cselect_b32 s3, s78, s77
    s_lshl_b32 s76, s44, 2
    s_add_u32 s76, s76, s72
    v_lshrrev_b32 v2, 3, v1
    v_and_b32 v3, 7, v1
    v_lshrrev_b32 v4, 4, v1
    v_lshrrev_b32 v5, 5, v1
    v_and_b32 v6, 31, v1
    v_lshlrev_b32 v7, 4, v1
    v_and_b32 v8, 15, v1
    v_mov_b32 v27, 162304
    s_lshl_b32 s78, s72, 2
    v_add_u32 v26, s78, v27
    s_cmp_lt_u32 s79, 4
    s_cbranch_scc1 L_fft
    s_setprio 1
    v_xor_b32 v17, v3, v4
    v_lshlrev_b32 v17, 4, v17
    s_mov_b32 s77, 114688
    v_mad_u32_u24 v9, v2, s77, v17
    v_xor_b32 v10, 64, v9
    v_add_u32 v10, 916480, v10
    v_add_u32 v11, 55296, v9
    v_add_u32 v12, 55296, v10
    s_mul_i32 s100, s76, 896
    v_add_u32 v9, s100, v9
    v_add_u32 v10, s100, v10
    v_add_u32 v11, s100, v11
    v_add_u32 v12, s100, v12
    s_mov_b32 s77, s3
    s_lshl_b32 s20, s77, 7
    s_add_u32 s77, s77, 1
    s_cmp_eq_u32 s77, 7
    s_cselect_b32 s77, 0, s77
    s_lshl_b32 s21, s77, 7
    s_add_u32 s77, s77, 1
    s_cmp_eq_u32 s77, 7
    s_cselect_b32 s77, 0, s77
    s_lshl_b32 s22, s77, 7
    s_add_u32 s77, s77, 1
    s_cmp_eq_u32 s77, 7
    s_cselect_b32 s77, 0, s77
    s_lshl_b32 s23, s77, 7
    s_add_u32 s77, s77, 1
    s_cmp_eq_u32 s77, 7
    s_cselect_b32 s77, 0, s77
    s_lshl_b32 s24, s77, 7
    s_add_u32 s77, s77, 1
    s_cmp_eq_u32 s77, 7
    s_cselect_b32 s77, 0, s77
    s_lshl_b32 s25, s77, 7
    s_add_u32 s77, s77, 1
    s_cmp_eq_u32 s77, 7
    s_cselect_b32 s77, 0, s77
    s_lshl_b32 s26, s77, 7
    s_lshl_b32 s101, s72, 12
    s_cmp_ge_u32 s72, 2
    s_mov_b32 s39, 114688
    s_cselect_b32 s39, 143360, s39
    s_add_u32 s27, s39, s101
    s_mov_b32 s97, s39
    s_waitcnt lgkmcnt(0)
    s_mov_b32 s32, s48
    s_mov_b32 s33, s49
    s_mov_b32 s34, 1835008
    s_mov_b32 s35, 0x20000
    s_mov_b32 s8, s56
    s_mov_b32 s9, s57
    s_mov_b32 s10, 1605632
    s_mov_b32 s11, 0x20000
    s_lshl_b32 s43, s2, 2
    s_add_u32 s43, s43, s72
    s_mul_i32 s49, s43, 1152
    s_mul_i32 s43, s43, 1792
    v_lshlrev_b32 v23, 7, v1
    s_add_u32 m0, s101, 0
    s_nop 0
    buffer_load_dwordx4 v9, s[32:35], s20 offen offset:0 lds
    buffer_load_dwordx4 v10, s[32:35], s20 offen offset:1024 lds
    buffer_load_dwordx4 v11, s[32:35], s20 offen offset:2048 lds
    buffer_load_dwordx4 v12, s[32:35], s20 offen offset:3072 lds
    s_mov_b64 exec, 0x3fff
    buffer_load_ubyte v140, v23, s[8:11], s43 offen
    s_mov_b64 exec, -1
    s_add_u32 m0, s101, 16384
    s_nop 0
    buffer_load_dwordx4 v9, s[32:35], s21 offen offset:0 lds
    buffer_load_dwordx4 v10, s[32:35], s21 offen offset:1024 lds
    buffer_load_dwordx4 v11, s[32:35], s21 offen offset:2048 lds
    buffer_load_dwordx4 v12, s[32:35], s21 offen offset:3072 lds
    s_add_u32 m0, s101, 32768
    s_nop 0
    buffer_load_dwordx4 v9, s[32:35], s22 offen offset:0 lds
    buffer_load_dwordx4 v10, s[32:35], s22 offen offset:1024 lds
    buffer_load_dwordx4 v11, s[32:35], s22 offen offset:2048 lds
    buffer_load_dwordx4 v12, s[32:35], s22 offen offset:3072 lds
    s_add_u32 m0, s101, 49152
    s_nop 0
    buffer_load_dwordx4 v9, s[32:35], s23 offen offset:0 lds
    buffer_load_dwordx4 v10, s[32:35], s23 offen offset:1024 lds
    buffer_load_dwordx4 v11, s[32:35], s23 offen offset:2048 lds
    buffer_load_dwordx4 v12, s[32:35], s23 offen offset:3072 lds
    s_barrier
    s_add_u32 m0, s101, 65536
    s_nop 0
    buffer_load_dwordx4 v9, s[32:35], s24 offen offset:0 lds
    buffer_load_dwordx4 v10, s[32:35], s24 offen offset:1024 lds
    buffer_load_dwordx4 v11, s[32:35], s24 offen offset:2048 lds
    buffer_load_dwordx4 v12, s[32:35], s24 offen offset:3072 lds
    s_add_u32 m0, s101, 81920
    s_nop 0
    buffer_load_dwordx4 v9, s[32:35], s25 offen offset:0 lds
    buffer_load_dwordx4 v10, s[32:35], s25 offen offset:1024 lds
    buffer_load_dwordx4 v11, s[32:35], s25 offen offset:2048 lds
    buffer_load_dwordx4 v12, s[32:35], s25 offen offset:3072 lds
    s_add_u32 m0, s101, 98304
    s_nop 0
    buffer_load_dwordx4 v9, s[32:35], s26 offen offset:0 lds
    buffer_load_dwordx4 v10, s[32:35], s26 offen offset:1024 lds
    buffer_load_dwordx4 v11, s[32:35], s26 offen offset:2048 lds
    buffer_load_dwordx4 v12, s[32:35], s26 offen offset:3072 lds
    s_waitcnt vmcnt(12)
    v_mov_b32 v28, 1
    ds_write_b32 v26, v28 offset:48
    s_mov_b32 s16, s70
    s_mov_b32 s17, s71
    s_mov_b32 s18, 16252928
    s_mov_b32 s19, 0x20000
    s_mov_b32 s36, s58
    s_mov_b32 s37, s59
    s_mov_b32 s38, 3584
    s_mov_b32 s39, 0x20000
    s_mov_b32 s12, s60
    s_mov_b32 s13, s61
    s_mov_b32 s14, 1605632
    s_mov_b32 s15, 0x20000
    s_mov_b32 s28, s66
    s_mov_b32 s29, s67
    s_mov_b32 s30, 1835008
    s_mov_b32 s31, 0x20000
    s_mov_b32 s4, s50
    s_mov_b32 s5, s51
    s_mov_b32 s6, 921600
    s_mov_b32 s7, 0x20000
    s_mov_b32 s32, s52
    s_mov_b32 s33, s53
    s_mov_b32 s34, 921600
    s_mov_b32 s35, 0x20000
    s_mov_b64 exec, 0x3fff
    buffer_load_ubyte v141, v23, s[12:15], s43 offen
    s_mov_b64 exec, -1
    s_mov_b64 exec, 0x1ff
    buffer_load_ubyte v142, v23, s[4:7], s49 offen
    s_mov_b64 exec, -1
    s_mov_b64 exec, 0x1ff
    buffer_load_ubyte v139, v23, s[32:35], s49 offen
    s_mov_b64 exec, -1
    s_lshl_b32 s50, s72, 12
    s_lshl_b32 s51, s72, 11
    v_and_b32 v17, 1, v4
    v_lshlrev_b32 v17, 2, v17
    v_xor_b32 v17, v3, v17
    v_lshlrev_b32 v17, 4, v17
    s_movk_i32 s77, 3584
    v_mad_u32_u24 v13, v2, s77, v17
    s_lshl_b32 s78, s45, 8
    v_add_u32 v13, s78, v13
    v_add_u32 v14, 27648, v13
    v_add_u32 v15, 55296, v13
    v_add_u32 v16, 82944, v13
    v_bfe_u32 v17, v1, 1, 3
    v_xor_b32 v17, v17, v5
    v_lshlrev_b32 v17, 4, v17
    v_lshl_add_u32 v17, v6, 7, v17
    v_add_u32 v17, s50, v17
    v_xor_b32 v18, 32, v17
    v_xor_b32 v19, 64, v17
    v_xor_b32 v20, 96, v17
    v_lshlrev_b32 v12, 2, v1
    s_lshl_b32 s78, s45, 8
    buffer_load_dword v24, off, s[16:19], 0 sc1
    buffer_load_dword v25, v12, s[36:39], s78 offen
    ds_read_b128 a[0:3], v17 offset:0
    ds_read_b128 a[4:7], v18 offset:0
    ds_read_b128 a[8:11], v19 offset:0
    ds_read_b128 a[12:15], v20 offset:0
    ds_read_b128 a[16:19], v17 offset:16384
    ds_read_b128 a[20:23], v18 offset:16384
    ds_read_b128 a[24:27], v19 offset:16384
    ds_read_b128 a[28:31], v20 offset:16384
    ds_read_b128 a[32:35], v17 offset:32768
    ds_read_b128 a[36:39], v18 offset:32768
    ds_read_b128 a[40:43], v19 offset:32768
    ds_read_b128 a[44:47], v20 offset:32768
    ds_read_b128 a[48:51], v17 offset:49152
    ds_read_b128 a[52:55], v18 offset:49152
    ds_read_b128 a[56:59], v19 offset:49152
    ds_read_b128 a[60:63], v20 offset:49152
    s_waitcnt vmcnt(5)
    v_mov_b32 v28, 2
    ds_write_b32 v26, v28 offset:48
    ds_read_b32 v28, v26 offset:16
    v_add_u32 v17, 65536, v17
    v_add_u32 v18, 65536, v18
    v_add_u32 v19, 65536, v19
    v_add_u32 v20, 65536, v20
    s_add_u32 s77, s72, 0
    s_sub_u32 s78, s77, 14
    s_cmp_ge_u32 s77, 14
    s_cselect_b32 s77, s78, s77
    s_cselect_b32 s79, 128, 0
    s_lshl_b32 s78, s3, 1
    s_add_u32 s77, s77, s78
    s_sub_u32 s78, s77, 14
    s_cmp_ge_u32 s77, 14
    s_cselect_b32 s77, s78, s77
    s_mul_i32 s77, s77, 114688
    s_add_u32 s60, s77, s79
    s_add_u32 m0, s50, 0
    s_waitcnt lgkmcnt(0)
    v_cmp_gt_u32 vcc, 4, v28
    s_nop 0
    s_cmp_eq_u64 vcc, 0
    s_cbranch_scc1 L_pd0
    s_mov_b32 s96, 300000
L_pl0:
    s_sleep 1
    ds_read_b32 v28, v26 offset:16
    s_waitcnt lgkmcnt(0)
    v_cmp_gt_u32 vcc, 4, v28
    s_sub_u32 s96, s96, 1
    s_cmp_eq_u32 s96, 0
    s_cbranch_scc1 L_pd0
    s_cmp_eq_u64 vcc, 0
    s_cbranch_scc0 L_pl0
L_pd0:
    ds_read_b128 a[64:67], v17 offset:0
    ds_read_b128 a[68:71], v18 offset:0
    ds_read_b128 a[72:75], v19 offset:0
    ds_read_b128 a[76:79], v20 offset:0
    ds_read_b128 a[80:83], v17 offset:16384
    ds_read_b128 a[84:87], v18 offset:16384
    ds_read_b128 a[88:91], v19 offset:16384
    ds_read_b128 a[92:95], v20 offset:16384
    ds_read_b128 a[96:99], v17 offset:32768
    ds_read_b128 a[100:103], v18 offset:32768
    ds_read_b128 a[104:107], v19 offset:32768
    ds_read_b128 a[108:111], v20 offset:32768
    buffer_load_dwordx4 v13, s[8:11], s60 offen offset:0 lds
    buffer_load_dwordx4 v14, s[8:11], s60 offen offset:1024 lds
    buffer_load_dwordx4 v15, s[8:11], s60 offen offset:2048 lds
    buffer_load_dwordx4 v16, s[8:11], s60 offen offset:3072 lds
    s_add_u32 s77, s72, 4
    s_sub_u32 s78, s77, 14
    s_cmp_ge_u32 s77, 14
    s_cselect_b32 s77, s78, s77
    s_cselect_b32 s79, 128, 0
    s_lshl_b32 s78, s3, 1
    s_add_u32 s77, s77, s78
    s_sub_u32 s78, s77, 14
    s_cmp_ge_u32 s77, 14
    s_cselect_b32 s77, s78, s77
    s_mul_i32 s77, s77, 114688
    s_add_u32 s60, s77, s79
    s_add_u32 m0, s50, 16384
    s_nop 0
    buffer_load_dwordx4 v13, s[8:11], s60 offen offset:0 lds
    buffer_load_dwordx4 v14, s[8:11], s60 offen offset:1024 lds
    buffer_load_dwordx4 v15, s[8:11], s60 offen offset:2048 lds
    buffer_load_dwordx4 v16, s[8:11], s60 offen offset:3072 lds
    v_bfe_u32 v21, v1, 2, 2
    v_lshl_add_u32 v21, v5, 3, v21
    v_lshlrev_b32 v21, 7, v21
    v_bfe_u32 v22, v1, 3, 1
    v_lshl_add_u32 v21, v22, 6, v21
    v_bfe_u32 v22, v1, 4, 1
    v_lshl_add_u32 v21, v22, 5, v21
    v_and_b32 v22, 3, v1
    v_lshl_add_u32 v21, v22, 3, v21
    v_xor_b32 v22, 64, v21
    s_waitcnt vmcnt(8)
    v_lshlrev_b32 v128, 16, v25
    v_and_b32 v129, 0xffff0000, v25
    v_lshlrev_b32 v130, 3, v1
    v_add_u32 v130, 161280, v130
    ds_write_b64 v130, v[128:129]
    v_lshlrev_b32 v130, 4, v5
    v_add_u32 v130, 161280, v130
    ds_read_b128 v[32:35], v130 offset:0
    ds_read_b128 v[36:39], v130 offset:32
    ds_read_b128 v[40:43], v130 offset:64
    ds_read_b128 v[44:47], v130 offset:96
    ds_read_b128 v[48:51], v130 offset:128
    ds_read_b128 v[52:55], v130 offset:160
    ds_read_b128 v[56:59], v130 offset:192
    ds_read_b128 v[60:63], v130 offset:224
    ds_read_b128 v[64:67], v130 offset:256
    ds_read_b128 v[68:71], v130 offset:288
    ds_read_b128 v[72:75], v130 offset:320
    ds_read_b128 v[76:79], v130 offset:352
    ds_read_b128 v[80:83], v130 offset:384
    ds_read_b128 v[84:87], v130 offset:416
    ds_read_b128 v[88:91], v130 offset:448
    ds_read_b128 v[92:95], v130 offset:480
    v_readfirstlane_b32 s77, v24
    s_nop 0
    s_add_u32 s75, s77, 1
    s_mul_i32 s77, s77, 0x9E3779B1
    s_add_u32 s73, s77, 0x7F4A7C15
    s_add_u32 s74, s73, 1
    v_mov_b32 v24, s73
    s_waitcnt vmcnt(4)
    v_mov_b32 v28, 1
    ds_write_b32 v26, v28 offset:0
    ds_read_b128 v[28:31], v27 offset:0
    s_waitcnt lgkmcnt(0)
    v_min_u32 v28, v28, v29
    v_min3_u32 v28, v28, v30, v31
    v_cmp_gt_u32 vcc, 1, v28
    s_nop 0
    s_cmp_eq_u64 vcc, 0
    s_cbranch_scc1 L_pd2
    s_mov_b32 s96, 300000
L_pl2:
    s_sleep 1
    ds_read_b128 v[28:31], v27 offset:0
    s_waitcnt lgkmcnt(0)
    v_min_u32 v28, v28, v29
    v_min3_u32 v28, v28, v30, v31
    v_cmp_gt_u32 vcc, 1, v28
    s_sub_u32 s96, s96, 1
    s_cmp_eq_u32 s96, 0
    s_cbranch_scc1 L_pd2
    s_cmp_eq_u64 vcc, 0
    s_cbranch_scc0 L_pl2
L_pd2:
    ds_read_b64_tr_b16 v[96:97], v21 offset:0
    ds_read_b64_tr_b16 v[98:99], v21 offset:512
    ds_read_b64_tr_b16 v[100:101], v22 offset:0
    ds_read_b64_tr_b16 v[102:103], v22 offset:512
    ds_read_b64_tr_b16 v[104:105], v21 offset:2048
    ds_read_b64_tr_b16 v[106:107], v21 offset:2560
    ds_read_b64_tr_b16 v[108:109], v22 offset:2048
    ds_read_b64_tr_b16 v[110:111], v22 offset:2560
    s_waitcnt lgkmcnt(6)
    v_mfma_f32_32x32x16_bf16 v[32:47], v[96:99], a[0:3], v[32:47]
    ds_read_b64_tr_b16 v[112:113], v21 offset:4096
    ds_read_b64_tr_b16 v[114:115], v21 offset:4608
    s_add_u32 s77, s72, 8
    s_sub_u32 s78, s77, 14
    s_cmp_ge_u32 s77, 14
    s_cselect_b32 s77, s78, s77
    s_cselect_b32 s79, 128, 0
    s_lshl_b32 s78, s3, 1
    s_add_u32 s77, s77, s78
    s_sub_u32 s78, s77, 14
    s_cmp_ge_u32 s77, 14
    s_cselect_b32 s77, s78, s77
    s_mul_i32 s77, s77, 114688
    s_add_u32 s60, s77, s79
    s_add_u32 m0, s50, 32768
    s_nop 0
    buffer_load_dwordx4 v13, s[8:11], s60 offen offset:0 lds
    s_waitcnt lgkmcnt(6)
    v_mfma_f32_32x32x16_bf16 v[48:63], v[100:103], a[0:3], v[48:63]
    ds_read_b64_tr_b16 v[116:117], v22 offset:4096
    ds_read_b64_tr_b16 v[118:119], v22 offset:4608
    buffer_load_dwordx4 v14, s[8:11], s60 offen offset:1024 lds
    s_waitcnt lgkmcnt(6)
    v_mfma_f32_32x32x16_bf16 v[32:47], v[104:107], a[4:7], v[32:47]
    ds_read_b64_tr_b16 v[120:121], v21 offset:6144
    ds_read_b64_tr_b16 v[122:123], v21 offset:6656
    s_waitcnt lgkmcnt(6)
    v_mfma_f32_32x32x16_bf16 v[48:63], v[108:111], a[4:7], v[48:63]
    ds_read_b64_tr_b16 v[124:125], v22 offset:6144
    ds_read_b64_tr_b16 v[126:127], v22 offset:6656
    buffer_load_dwordx4 v15, s[8:11], s60 offen offset:2048 lds
    s_waitcnt lgkmcnt(6)
    v_mfma_f32_32x32x16_bf16 v[32:47], v[112:115], a[8:11], v[32:47]
    ds_read_b64_tr_b16 v[96:97], v21 offset:8192
    ds_read_b64_tr_b16 v[98:99], v21 offset:8704
    buffer_load_dwordx4 v16, s[8:11], s60 offen offset:3072 lds
    s_waitcnt lgkmcnt(6)
    v_mfma_f32_32x32x16_bf16 v[48:63], v[116:119], a[8:11], v[48:63]
    ds_read_b64_tr_b16 v[100:101], v22 offset:8192
    ds_read_b64_tr_b16 v[102:103], v22 offset:8704
    s_waitcnt vmcnt(4)
    v_mov_b32 v28, 2
    ds_write_b32 v26, v28 offset:0
    s_waitcnt lgkmcnt(7)
    v_mfma_f32_32x32x16_bf16 v[32:47], v[120:123], a[12:15], v[32:47]
    ds_read_b64_tr_b16 v[104:105], v21 offset:10240
    ds_read_b64_tr_b16 v[106:107], v21 offset:10752
    s_add_u32 s77, s72, 12
    s_sub_u32 s78, s77, 14
    s_cmp_ge_u32 s77, 14
    s_cselect_b32 s77, s78, s77
    s_cselect_b32 s79, 128, 0
    s_lshl_b32 s78, s3, 1
    s_add_u32 s77, s77, s78
    s_sub_u32 s78, s77, 14
    s_cmp_ge_u32 s77, 14
    s_cselect_b32 s77, s78, s77
    s_mul_i32 s77, s77, 114688
    s_add_u32 s60, s77, s79
    s_add_u32 m0, s50, 49152
    s_nop 0
    buffer_load_dwordx4 v13, s[8:11], s60 offen offset:0 lds
    s_waitcnt lgkmcnt(7)
    v_mfma_f32_32x32x16_bf16 v[48:63], v[124:127], a[12:15], v[48:63]
    ds_read_b64_tr_b16 v[108:109], v22 offset:10240
    ds_read_b64_tr_b16 v[110:111], v22 offset:10752
    buffer_load_dwordx4 v14, s[8:11], s60 offen offset:1024 lds
    ds_read_b128 v[28:31], v27 offset:0
    s_waitcnt lgkmcnt(8)
    v_mfma_f32_32x32x16_bf16 v[32:47], v[96:99], a[16:19], v[32:47]
    ds_read_b64_tr_b16 v[112:113], v21 offset:12288
    ds_read_b64_tr_b16 v[114:115], v21 offset:12800
    s_waitcnt lgkmcnt(8)
    v_mfma_f32_32x32x16_bf16 v[48:63], v[100:103], a[16:19], v[48:63]
    ds_read_b64_tr_b16 v[116:117], v22 offset:12288
    ds_read_b64_tr_b16 v[118:119], v22 offset:12800
    buffer_load_dwordx4 v15, s[8:11], s60 offen offset:2048 lds
    s_waitcnt lgkmcnt(7)
    v_mfma_f32_32x32x16_bf16 v[32:47], v[104:107], a[20:23], v[32:47]
    ds_read_b64_tr_b16 v[120:121], v21 offset:14336
    ds_read_b64_tr_b16 v[122:123], v21 offset:14848
    buffer_load_dwordx4 v16, s[8:11], s60 offen offset:3072 lds
    s_waitcnt lgkmcnt(7)
    v_mfma_f32_32x32x16_bf16 v[48:63], v[108:111], a[20:23], v[48:63]
    ds_read_b64_tr_b16 v[124:125], v22 offset:14336
    ds_read_b64_tr_b16 v[126:127], v22 offset:14848
    s_waitcnt lgkmcnt(8)
    v_min_u32 v28, v28, v29
    v_min3_u32 v28, v28, v30, v31
    v_cmp_gt_u32 vcc, 2, v28
    s_nop 0
    s_cmp_eq_u64 vcc, 0
    s_cbranch_scc1 L_pd3
    s_mov_b32 s96, 300000
L_pl3:
    s_sleep 1
    ds_read_b128 v[28:31], v27 offset:0
    s_waitcnt lgkmcnt(0)
    v_min_u32 v28, v28, v29
    v_min3_u32 v28, v28, v30, v31
    v_cmp_gt_u32 vcc, 2, v28
    s_sub_u32 s96, s96, 1
    s_cmp_eq_u32 s96, 0
    s_cbranch_scc1 L_pd3
    s_cmp_eq_u64 vcc, 0
    s_cbranch_scc0 L_pl3
L_pd3:
    s_waitcnt lgkmcnt(6)
    v_mfma_f32_32x32x16_bf16 v[32:47], v[112:115], a[24:27], v[32:47]
    ds_read_b64_tr_b16 v[96:97], v21 offset:16384
    ds_read_b64_tr_b16 v[98:99], v21 offset:16896
    s_waitcnt lgkmcnt(6)
    v_mfma_f32_32x32x16_bf16 v[48:63], v[116:119], a[24:27], v[48:63]
    ds_read_b64_tr_b16 v[100:101], v22 offset:16384
    ds_read_b64_tr_b16 v[102:103], v22 offset:16896
    s_waitcnt lgkmcnt(6)
    v_mfma_f32_32x32x16_bf16 v[32:47], v[120:123], a[28:31], v[32:47]
    ds_read_b64_tr_b16 v[104:105], v21 offset:18432
    ds_read_b64_tr_b16 v[106:107], v21 offset:18944
    ds_read_b32 v28, v26 offset:16
    s_add_u32 s77, s72, 16
    s_sub_u32 s78, s77, 14
    s_cmp_ge_u32 s77, 14
    s_cselect_b32 s77, s78, s77
    s_cselect_b32 s79, 128, 0
    s_lshl_b32 s78, s3, 1
    s_add_u32 s77, s77, s78
    s_sub_u32 s78, s77, 14
    s_cmp_ge_u32 s77, 14
    s_cselect_b32 s77, s78, s77
    s_mul_i32 s77, s77, 114688
    s_add_u32 s60, s77, s79
    s_add_u32 m0, s50, 65536
    s_waitcnt lgkmcnt(0)
    v_cmp_gt_u32 vcc, 7, v28
    s_nop 0
    s_cmp_eq_u64 vcc, 0
    s_cbranch_scc1 L_pd1
    s_mov_b32 s96, 300000
L_pl1:
    s_sleep 1
    ds_read_b32 v28, v26 offset:16
    s_waitcnt lgkmcnt(0)
    v_cmp_gt_u32 vcc, 7, v28
    s_sub_u32 s96, s96, 1
    s_cmp_eq_u32 s96, 0
    s_cbranch_scc1 L_pd1
    s_cmp_eq_u64 vcc, 0
    s_cbranch_scc0 L_pl1
L_pd1:
    buffer_load_dwordx4 v13, s[8:11], s60 offen offset:0 lds
    v_mfma_f32_32x32x16_bf16 v[48:63], v[124:127], a[28:31], v[48:63]
    ds_read_b64_tr_b16 v[108:109], v22 offset:18432
    ds_read_b64_tr_b16 v[110:111], v22 offset:18944
    buffer_load_dwordx4 v14, s[8:11], s60 offen offset:1024 lds
    v_mfma_f32_32x32x16_bf16 v[32:47], v[96:99], a[32:35], v[32:47]
    ds_read_b64_tr_b16 v[112:113], v21 offset:20480
    ds_read_b64_tr_b16 v[114:115], v21 offset:20992
    v_mfma_f32_32x32x16_bf16 v[48:63], v[100:103], a[32:35], v[48:63]
    ds_read_b64_tr_b16 v[116:117], v22 offset:20480
    ds_read_b64_tr_b16 v[118:119], v22 offset:20992
    buffer_load_dwordx4 v15, s[8:11], s60 offen offset:2048 lds
    v_mfma_f32_32x32x16_bf16 v[32:47], v[104:107], a[36:39], v[32:47]
    ds_read_b64_tr_b16 v[120:121], v21 offset:22528
    ds_read_b64_tr_b16 v[122:123], v21 offset:23040
    s_waitcnt lgkmcnt(6)
    v_mfma_f32_32x32x16_bf16 v[48:63], v[108:111], a[36:39], v[48:63]
    ds_read_b64_tr_b16 v[124:125], v22 offset:22528
    ds_read_b64_tr_b16 v[126:127], v22 offset:23040
    buffer_load_dwordx4 v16, s[8:11], s60 offen offset:3072 lds
    s_waitcnt lgkmcnt(6)
    v_mfma_f32_32x32x16_bf16 v[32:47], v[112:115], a[40:43], v[32:47]
    ds_read_b64_tr_b16 v[96:97], v21 offset:24576
    ds_read_b64_tr_b16 v[98:99], v21 offset:25088
    s_add_u32 s77, s72, 20
    s_sub_u32 s78, s77, 14
    s_cmp_ge_u32 s77, 14
    s_cselect_b32 s77, s78, s77
    s_cselect_b32 s79, 128, 0
    s_lshl_b32 s78, s3, 1
    s_add_u32 s77, s77, s78
    s_sub_u32 s78, s77, 14
    s_cmp_ge_u32 s77, 14
    s_cselect_b32 s77, s78, s77
    s_mul_i32 s77, s77, 114688
    s_add_u32 s60, s77, s79
    s_add_u32 m0, s50, 81920
    s_nop 0
    buffer_load_dwordx4 v13, s[8:11], s60 offen offset:0 lds
    s_waitcnt lgkmcnt(6)
    v_mfma_f32_32x32x16_bf16 v[48:63], v[116:119], a[40:43], v[48:63]
    ds_read_b64_tr_b16 v[100:101], v22 offset:24576
    ds_read_b64_tr_b16 v[102:103], v22 offset:25088
    s_waitcnt vmcnt(5)
    v_mov_b32 v28, 4
    ds_write_b32 v26, v28 offset:0
    s_waitcnt lgkmcnt(7)
    v_mfma_f32_32x32x16_bf16 v[32:47], v[120:123], a[44:47], v[32:47]
    ds_read_b64_tr_b16 v[104:105], v21 offset:26624
    ds_read_b64_tr_b16 v[106:107], v21 offset:27136
    buffer_load_dwordx4 v14, s[8:11], s60 offen offset:1024 lds
    s_waitcnt lgkmcnt(7)
    v_mfma_f32_32x32x16_bf16 v[48:63], v[124:127], a[44:47], v[48:63]
    ds_read_b64_tr_b16 v[108:109], v22 offset:26624
    ds_read_b64_tr_b16 v[110:111], v22 offset:27136
    ds_read_b128 v[28:31], v27 offset:0
    s_waitcnt lgkmcnt(8)
    v_mfma_f32_32x32x16_bf16 v[32:47], v[96:99], a[48:51], v[32:47]
    ds_read_b64_tr_b16 v[112:113], v21 offset:28672
    ds_read_b64_tr_b16 v[114:115], v21 offset:29184
    buffer_load_dwordx4 v15, s[8:11], s60 offen offset:2048 lds
    s_waitcnt lgkmcnt(8)
    v_mfma_f32_32x32x16_bf16 v[48:63], v[100:103], a[48:51], v[48:63]
    ds_read_b64_tr_b16 v[116:117], v22 offset:28672
    ds_read_b64_tr_b16 v[118:119], v22 offset:29184
    buffer_load_dwordx4 v16, s[8:11], s60 offen offset:3072 lds
    s_waitcnt lgkmcnt(7)
    v_mfma_f32_32x32x16_bf16 v[32:47], v[104:107], a[52:55], v[32:47]
    ds_read_b64_tr_b16 v[120:121], v21 offset:30720
    ds_read_b64_tr_b16 v[122:123], v21 offset:31232
    s_waitcnt lgkmcnt(7)
    v_mfma_f32_32x32x16_bf16 v[48:63], v[108:111], a[52:55], v[48:63]
    ds_read_b64_tr_b16 v[124:125], v22 offset:30720
    ds_read_b64_tr_b16 v[126:127], v22 offset:31232
    s_add_u32 s77, s72, 24
    s_sub_u32 s78, s77, 14
    s_cmp_ge_u32 s77, 14
    s_cselect_b32 s77, s78, s77
    s_cselect_b32 s79, 128, 0
    s_lshl_b32 s78, s3, 1
    s_add_u32 s77, s77, s78
    s_sub_u32 s78, s77, 14
    s_cmp_ge_u32 s77, 14
    s_cselect_b32 s77, s78, s77
    s_mul_i32 s77, s77, 114688
    s_add_u32 s60, s77, s79
    s_add_u32 m0, s50, 98304
    s_nop 0
    buffer_load_dwordx4 v13, s[8:11], s60 offen offset:0 lds
    s_waitcnt lgkmcnt(8)
    v_min_u32 v28, v28, v29
    v_min3_u32 v28, v28, v30, v31
    v_cmp_gt_u32 vcc, 4, v28
    s_nop 0
    s_cmp_eq_u64 vcc, 0
    s_cbranch_scc1 L_pd4
    s_mov_b32 s96, 300000
L_pl4:
    s_sleep 1
    ds_read_b128 v[28:31], v27 offset:0
    s_waitcnt lgkmcnt(0)
    v_min_u32 v28, v28, v29
    v_min3_u32 v28, v28, v30, v31
    v_cmp_gt_u32 vcc, 4, v28
    s_sub_u32 s96, s96, 1
    s_cmp_eq_u32 s96, 0
    s_cbranch_scc1 L_pd4
    s_cmp_eq_u64 vcc, 0
    s_cbranch_scc0 L_pl4
L_pd4:
    s_waitcnt lgkmcnt(6)
    v_mfma_f32_32x32x16_bf16 v[32:47], v[112:115], a[56:59], v[32:47]
    ds_read_b64_tr_b16 v[96:97], v21 offset:32768
    ds_read_b64_tr_b16 v[98:99], v21 offset:33280
    s_waitcnt lgkmcnt(6)
    v_mfma_f32_32x32x16_bf16 v[48:63], v[116:119], a[56:59], v[48:63]
    ds_read_b64_tr_b16 v[100:101], v22 offset:32768
    ds_read_b64_tr_b16 v[102:103], v22 offset:33280
    buffer_load_dwordx4 v14, s[8:11], s60 offen offset:1024 lds
    s_waitcnt lgkmcnt(6)
    v_mfma_f32_32x32x16_bf16 v[32:47], v[120:123], a[60:63], v[32:47]
    ds_read_b64_tr_b16 v[104:105], v21 offset:34816
    ds_read_b64_tr_b16 v[106:107], v21 offset:35328
    buffer_load_dwordx4 v15, s[8:11], s60 offen offset:2048 lds
    s_waitcnt lgkmcnt(6)
    v_mfma_f32_32x32x16_bf16 v[48:63], v[124:127], a[60:63], v[48:63]
    ds_read_b64_tr_b16 v[108:109], v22 offset:34816
    ds_read_b64_tr_b16 v[110:111], v22 offset:35328
    s_waitcnt lgkmcnt(6)
    v_mfma_f32_32x32x16_bf16 v[32:47], v[96:99], a[64:67], v[32:47]
    ds_read_b64_tr_b16 v[112:113], v21 offset:36864
    ds_read_b64_tr_b16 v[114:115], v21 offset:37376
    buffer_load_dwordx4 v16, s[8:11], s60 offen offset:3072 lds
    s_waitcnt lgkmcnt(6)
    v_mfma_f32_32x32x16_bf16 v[48:63], v[100:103], a[64:67], v[48:63]
    ds_read_b64_tr_b16 v[116:117], v22 offset:36864
    ds_read_b64_tr_b16 v[118:119], v22 offset:37376
    ds_read_b128 v[28:31], v27 offset:16
    s_waitcnt lgkmcnt(7)
    v_mfma_f32_32x32x16_bf16 v[32:47], v[104:107], a[68:71], v[32:47]
    ds_read_b64_tr_b16 v[120:121], v21 offset:38912
    ds_read_b64_tr_b16 v[122:123], v21 offset:39424
    s_lshl_b32 s4, s20, 6
    s_lshl_b32 s5, s21, 6
    s_lshl_b32 s6, s22, 6
    s_lshl_b32 s7, s23, 6
    s_lshl_b32 s40, s24, 6
    s_lshl_b32 s41, s25, 6
    s_waitcnt lgkmcnt(7)
    v_mfma_f32_32x32x16_bf16 v[48:63], v[108:111], a[68:71], v[48:63]
    ds_read_b64_tr_b16 v[124:125], v22 offset:38912
    ds_read_b64_tr_b16 v[126:127], v22 offset:39424
    s_lshl_b32 s42, s26, 6
    s_mul_i32 s20, s20, 896
    s_mul_i32 s21, s21, 896
    s_mul_i32 s22, s22, 896
    s_mul_i32 s23, s23, 896
    s_mul_i32 s24, s24, 896
    s_waitcnt lgkmcnt(7)
    v_mfma_f32_32x32x16_bf16 v[32:47], v[112:115], a[72:75], v[32:47]
    ds_read_b64_tr_b16 v[96:97], v21 offset:40960
    ds_read_b64_tr_b16 v[98:99], v21 offset:41472
    s_mul_i32 s25, s25, 896
    s_mul_i32 s26, s26, 896
    s_mul_i32 s53, s46, 896
    s_lshl_b32 s78, s72, 4
    s_add_u32 s53, s53, s78
    s_mul_i32 s53, s53, 896
    s_waitcnt lgkmcnt(7)
    v_mfma_f32_32x32x16_bf16 v[48:63], v[116:119], a[72:75], v[48:63]
    ds_read_b64_tr_b16 v[100:101], v22 offset:40960
    ds_read_b64_tr_b16 v[102:103], v22 offset:41472
    s_lshl_b32 s78, s47, 7
    s_add_u32 s53, s53, s78
    v_lshlrev_b32 v9, 1, v4
    v_xor_b32 v9, v3, v9
    v_lshl_add_u32 v9, v9, 4, s53
    s_waitcnt lgkmcnt(8)
    v_min_u32 v28, v28, v29
    v_min3_u32 v28, v28, v30, v31
    v_cmp_gt_u32 vcc, 7, v28
    s_nop 0
    s_cmp_eq_u64 vcc, 0
    s_cbranch_scc1 L_pd5
    s_mov_b32 s96, 300000
L_pl5:
    s_sleep 1
    ds_read_b128 v[28:31], v27 offset:16
    s_waitcnt lgkmcnt(0)
    v_min_u32 v28, v28, v29
    v_min3_u32 v28, v28, v30, v31
    v_cmp_gt_u32 vcc, 7, v28
    s_sub_u32 s96, s96, 1
    s_cmp_eq_u32 s96, 0
    s_cbranch_scc1 L_pd5
    s_cmp_eq_u64 vcc, 0
    s_cbranch_scc0 L_pl5
L_pd5:
    s_waitcnt lgkmcnt(6)
    v_mfma_f32_32x32x16_bf16 v[32:47], v[120:123], a[76:79], v[32:47]
    ds_read_b64_tr_b16 v[104:105], v21 offset:43008
    ds_read_b64_tr_b16 v[106:107], v21 offset:43520
    s_movk_i32 s78, 896
    v_mad_u32_u24 v9, v2, s78, v9
    v_add_u32 v10, 6144, v9
    v_add_u32 v11, 57344, v9
    v_add_u32 v12, 57344, v10
    v_mov_b32 v23, 0xbdd2d3e8
    s_waitcnt lgkmcnt(6)
    v_mfma_f32_32x32x16_bf16 v[48:63], v[124:127], a[76:79], v[48:63]
    ds_read_b64_tr_b16 v[108:109], v22 offset:43008
    ds_read_b64_tr_b16 v[110:111], v22 offset:43520
    s_mul_i32 s58, s76, 56
    s_lshl_b32 s78, s45, 2
    s_add_u32 s58, s58, s78
    s_lshl_b32 s58, s58, 11
    s_add_u32 s58, s58, 4718592
    s_add_u32 s59, s58, 4096
    s_waitcnt lgkmcnt(6)
    v_mfma_f32_32x32x16_bf16 v[32:47], v[96:99], a[80:83], v[32:47]
    ds_read_b64_tr_b16 v[112:113], v21 offset:45056
    ds_read_b64_tr_b16 v[114:115], v21 offset:45568
    s_lshl_b32 s61, s76, 4
    s_add_u32 s61, s61, s45
    s_lshl_b32 s61, s61, 7
    s_add_u32 s61, s61, 524288
    s_lshl_b32 s62, s44, 4
    s_add_u32 s62, s62, s45
    s_waitcnt lgkmcnt(6)
    v_mfma_f32_32x32x16_bf16 v[48:63], v[100:103], a[80:83], v[48:63]
    ds_read_b64_tr_b16 v[116:117], v22 offset:45056
    ds_read_b64_tr_b16 v[118:119], v22 offset:45568
    s_lshl_b32 s62, s62, 2
    s_add_u32 s62, s62, s72
    s_lshl_b32 s63, s62, 12
    s_add_u32 s63, s63, 12058624
    s_lshr_b32 s78, s72, 1
    s_waitcnt lgkmcnt(6)
    v_mfma_f32_32x32x16_bf16 v[32:47], v[104:107], a[84:87], v[32:47]
    ds_read_b64_tr_b16 v[120:121], v21 offset:47104
    ds_read_b64_tr_b16 v[122:123], v21 offset:47616
    s_lshl_b32 s79, s44, 2
    s_add_u32 s78, s78, s79
    s_lshl_b32 s79, s46, 1
    s_add_u32 s55, s78, s79
    s_xor_b32 s54, s55, 2
    s_lshl_b32 s65, s78, 4
    s_waitcnt lgkmcnt(6)
    v_mfma_f32_32x32x16_bf16 v[48:63], v[108:111], a[84:87], v[48:63]
    ds_read_b64_tr_b16 v[124:125], v22 offset:47104
    ds_read_b64_tr_b16 v[126:127], v22 offset:47616
    s_mul_i32 s79, s46, 7
    s_add_u32 s65, s65, s79
    s_lshl_b32 s65, s65, 7
    s_add_u32 s65, s65, 524288
    s_mov_b32 s64, s55
    s_mul_i32 s79, s46, 28
    s_waitcnt lgkmcnt(6)
    v_mfma_f32_32x32x16_bf16 v[32:47], v[112:115], a[88:91], v[32:47]
    ds_read_b64_tr_b16 v[96:97], v21 offset:49152
    ds_read_b64_tr_b16 v[98:99], v21 offset:49664
    s_and_b32 s78, s72, 1
    s_lshl_b32 s78, s78, 8
    s_add_u32 s78, s78, 4718592
    s_mul_i32 s54, s54, 56
    s_add_u32 s54, s54, s79
    s_lshl_b32 s54, s54, 11
    s_waitcnt lgkmcnt(6)
    v_mfma_f32_32x32x16_bf16 v[48:63], v[116:119], a[88:91], v[48:63]
    ds_read_b64_tr_b16 v[100:101], v22 offset:49152
    ds_read_b64_tr_b16 v[102:103], v22 offset:49664
    s_add_u32 s54, s54, s78
    s_mul_i32 s55, s55, 56
    s_add_u32 s55, s55, s79
    s_lshl_b32 s55, s55, 11
    s_add_u32 s55, s55, s78
    s_waitcnt lgkmcnt(6)
    v_mfma_f32_32x32x16_bf16 v[32:47], v[120:123], a[92:95], v[32:47]
    ds_read_b64_tr_b16 v[104:105], v21 offset:51200
    ds_read_b64_tr_b16 v[106:107], v21 offset:51712
    s_add_u32 m0, s51, 122880
    s_nop 0
    buffer_load_dwordx4 v9, s[12:15], s20 offen offset:0 lds
    s_waitcnt lgkmcnt(6)
    v_mfma_f32_32x32x16_bf16 v[48:63], v[124:127], a[92:95], v[48:63]
    ds_read_b64_tr_b16 v[108:109], v22 offset:51200
    ds_read_b64_tr_b16 v[110:111], v22 offset:51712
    buffer_load_dwordx4 v10, s[12:15], s20 offen offset:1024 lds
    s_waitcnt lgkmcnt(6)
    v_mfma_f32_32x32x16_bf16 v[32:47], v[96:99], a[96:99], v[32:47]
    ds_read_b64_tr_b16 v[112:113], v21 offset:53248
    ds_read_b64_tr_b16 v[114:115], v21 offset:53760
    s_waitcnt lgkmcnt(6)
    v_mfma_f32_32x32x16_bf16 v[48:63], v[100:103], a[96:99], v[48:63]
    ds_read_b64_tr_b16 v[116:117], v22 offset:53248
    ds_read_b64_tr_b16 v[118:119], v22 offset:53760
    s_add_u32 m0, s51, 131072
    s_nop 0
    buffer_load_dwordx4 v9, s[12:15], s21 offen offset:0 lds
    s_waitcnt lgkmcnt(6)
    v_mfma_f32_32x32x16_bf16 v[32:47], v[104:107], a[100:103], v[32:47]
    ds_read_b64_tr_b16 v[120:121], v21 offset:55296
    ds_read_b64_tr_b16 v[122:123], v21 offset:55808
    s_waitcnt lgkmcnt(6)
    v_mfma_f32_32x32x16_bf16 v[48:63], v[108:111], a[100:103], v[48:63]
    ds_read_b64_tr_b16 v[124:125], v22 offset:55296
    ds_read_b64_tr_b16 v[126:127], v22 offset:55808
    buffer_load_dwordx4 v10, s[12:15], s21 offen offset:1024 lds
    s_waitcnt lgkmcnt(6)
    v_mfma_f32_32x32x16_bf16 v[32:47], v[112:115], a[104:107], v[32:47]
    v_add_u32 v21, 57344, v21
    v_add_u32 v22, 57344, v22
    ds_read_b64_tr_b16 v[96:97], v21 offset:0
    ds_read_b64_tr_b16 v[98:99], v21 offset:512
    s_add_u32 m0, s51, 139264
    s_nop 0
    buffer_load_dwordx4 v9, s[12:15], s22 offen offset:0 lds
    s_waitcnt lgkmcnt(6)
    v_mfma_f32_32x32x16_bf16 v[48:63], v[116:119], a[104:107], v[48:63]
    ds_read_b64_tr_b16 v[100:101], v22 offset:0
    ds_read_b64_tr_b16 v[102:103], v22 offset:512
    s_waitcnt vmcnt(5)
    v_mov_b32 v28, 7
    ds_write_b32 v26, v28 offset:0
    s_waitcnt lgkmcnt(7)
    v_mfma_f32_32x32x16_bf16 v[32:47], v[120:123], a[108:111], v[32:47]
    ds_read_b64_tr_b16 v[104:105], v21 offset:2048
    ds_read_b64_tr_b16 v[106:107], v21 offset:2560
    buffer_load_dwordx4 v10, s[12:15], s22 offen offset:1024 lds
    s_waitcnt lgkmcnt(7)
    v_mfma_f32_32x32x16_bf16 v[48:63], v[124:127], a[108:111], v[48:63]
    ds_read_b64_tr_b16 v[108:109], v22 offset:2048
    ds_read_b64_tr_b16 v[110:111], v22 offset:2560
    v_lshlrev_b32 v13, 4, v8
    v_lshl_add_u32 v13, v4, 9, v13
    v_add_u32 v15, s55, v13
    v_add_u32 v13, s54, v13
    v_add_u32 v14, 4096, v13
    v_add_u32 v16, 4096, v15
    v_bfe_u32 v17, v1, 2, 2
    v_lshl_add_u32 v17, v5, 4, v17
    v_bfe_u32 v18, v1, 4, 1
    v_lshl_add_u32 v17, v18, 2, v17
    v_lshlrev_b32 v17, 7, v17
    v_bfe_u32 v18, v1, 3, 2
    v_lshl_add_u32 v17, v18, 5, v17
    v_and_b32 v18, 3, v1
    v_lshl_add_u32 v17, v18, 3, v17
    v_add_u32 v17, 122880, v17
    v_xor_b32 v18, 32, v17
    v_xor_b32 v19, 64, v17
    v_xor_b32 v20, 96, v17
    v_lshlrev_b32 v5, 7, v1
    v_min_u32 v25, 6, v3
    v_and_b32 v6, 1, v2
    v_lshl_add_u32 v25, v6, 5, v25
    v_lshlrev_b32 v25, 7, v25
    s_add_u32 s68, s65, 131072
    s_add_u32 s69, s65, 262144
    s_add_u32 s70, s65, 393216
    s_mov_b32 s66, 0xbdd2d3e8
    s_mov_b32 s67, 0xc0135761
    ds_read_b128 v[28:31], v27 offset:0
    s_waitcnt lgkmcnt(8)
    v_mfma_f32_32x32x16_bf16 v[64:79], v[96:99], a[0:3], v[64:79]
    ds_read_b64_tr_b16 v[112:113], v21 offset:4096
    ds_read_b64_tr_b16 v[114:115], v21 offset:4608
    v_pk_mul_f32 v[128:129], v[32:33], v[32:33]
    v_pk_mul_f32 v[130:131], v[34:35], v[34:35]
    v_pk_fma_f32 v[128:129], v[128:129], s[66:67], s[66:67] op_sel:[0,0,1] op_sel_hi:[1,0,1]
    v_pk_fma_f32 v[130:131], v[130:131], s[66:67], s[66:67] op_sel:[0,0,1] op_sel_hi:[1,0,1]
    v_pk_mul_f32 v[128:129], v[128:129], v[32:33]
    s_waitcnt lgkmcnt(8)
    v_mfma_f32_32x32x16_bf16 v[80:95], v[100:103], a[0:3], v[80:95]
    ds_read_b64_tr_b16 v[116:117], v22 offset:4096
    ds_read_b64_tr_b16 v[118:119], v22 offset:4608
    v_pk_mul_f32 v[130:131], v[130:131], v[34:35]
    v_exp_f32 v128, v128
    v_exp_f32 v129, v129
    s_waitcnt lgkmcnt(7)
    v_mfma_f32_32x32x16_bf16 v[64:79], v[104:107], a[4:7], v[64:79]
    ds_read_b64_tr_b16 v[120:121], v21 offset:6144
    ds_read_b64_tr_b16 v[122:123], v21 offset:6656
    v_exp_f32 v130, v130
    v_exp_f32 v131, v131
    v_pk_add_f32 v[128:129], v[128:129], 1.0 op_sel_hi:[1,0]
    s_waitcnt lgkmcnt(7)
    v_mfma_f32_32x32x16_bf16 v[80:95], v[108:111], a[4:7], v[80:95]
    ds_read_b64_tr_b16 v[124:125], v22 offset:6144
    ds_read_b64_tr_b16 v[126:127], v22 offset:6656
    v_pk_add_f32 v[130:131], v[130:131], 1.0 op_sel_hi:[1,0]
    v_rcp_f32 v128, v128
    v_rcp_f32 v129, v129
    s_waitcnt lgkmcnt(8)
    v_min_u32 v28, v28, v29
    v_min3_u32 v28, v28, v30, v31
    v_cmp_gt_u32 vcc, 7, v28
    s_nop 0
    s_cmp_eq_u64 vcc, 0
    s_cbranch_scc1 L_pd6
    s_mov_b32 s96, 300000
L_pl6:
    s_sleep 1
    ds_read_b128 v[28:31], v27 offset:0
    s_waitcnt lgkmcnt(0)
    v_min_u32 v28, v28, v29
    v_min3_u32 v28, v28, v30, v31
    v_cmp_gt_u32 vcc, 7, v28
    s_sub_u32 s96, s96, 1
    s_cmp_eq_u32 s96, 0
    s_cbranch_scc1 L_pd6
    s_cmp_eq_u64 vcc, 0
    s_cbranch_scc0 L_pl6
L_pd6:
    s_waitcnt lgkmcnt(6)
    v_mfma_f32_32x32x16_bf16 v[64:79], v[112:115], a[8:11], v[64:79]
    ds_read_b64_tr_b16 v[96:97], v21 offset:8192
    ds_read_b64_tr_b16 v[98:99], v21 offset:8704
    v_rcp_f32 v130, v130
    v_rcp_f32 v131, v131
    s_waitcnt lgkmcnt(6)
    v_mfma_f32_32x32x16_bf16 v[80:95], v[116:119], a[8:11], v[80:95]
    ds_read_b64_tr_b16 v[100:101], v22 offset:8192
    ds_read_b64_tr_b16 v[102:103], v22 offset:8704
    v_pk_mul_f32 v[32:33], v[128:129], v[32:33]
    v_pk_mul_f32 v[34:35], v[130:131], v[34:35]
    v_cvt_pk_bf16_f32 v32, v32, v33
    v_cvt_pk_bf16_f32 v33, v34, v35
    v_pk_mul_f32 v[132:133], v[36:37], v[36:37]
    v_mov_b32 v28, 1
    ds_write_b32 v26, v28 offset:32
    s_waitcnt lgkmcnt(7)
    v_mfma_f32_32x32x16_bf16 v[64:79], v[120:123], a[12:15], v[64:79]
    ds_read_b64_tr_b16 v[104:105], v21 offset:10240
    ds_read_b64_tr_b16 v[106:107], v21 offset:10752
    v_pk_mul_f32 v[134:135], v[38:39], v[38:39]
    v_pk_fma_f32 v[132:133], v[132:133], s[66:67], s[66:67] op_sel:[0,0,1] op_sel_hi:[1,0,1]
    v_pk_fma_f32 v[134:135], v[134:135], s[66:67], s[66:67] op_sel:[0,0,1] op_sel_hi:[1,0,1]
    v_pk_mul_f32 v[132:133], v[132:133], v[36:37]
    v_pk_mul_f32 v[134:135], v[134:135], v[38:39]
    s_waitcnt lgkmcnt(7)
    v_mfma_f32_32x32x16_bf16 v[80:95], v[124:127], a[12:15], v[80:95]
    ds_read_b64_tr_b16 v[108:109], v22 offset:10240
    ds_read_b64_tr_b16 v[110:111], v22 offset:10752
    v_exp_f32 v132, v132
    v_exp_f32 v133, v133
    ds_read_b128 v[28:31], v27 offset:32
    s_waitcnt lgkmcnt(8)
    v_mfma_f32_32x32x16_bf16 v[64:79], v[96:99], a[16:19], v[64:79]
    ds_read_b64_tr_b16 v[112:113], v21 offset:12288
    ds_read_b64_tr_b16 v[114:115], v21 offset:12800
    v_exp_f32 v134, v134
    v_exp_f32 v135, v135
    v_pk_add_f32 v[132:133], v[132:133], 1.0 op_sel_hi:[1,0]
    s_waitcnt lgkmcnt(8)
    v_mfma_f32_32x32x16_bf16 v[80:95], v[100:103], a[16:19], v[80:95]
    ds_read_b64_tr_b16 v[116:117], v22 offset:12288
    ds_read_b64_tr_b16 v[118:119], v22 offset:12800
    v_pk_add_f32 v[134:135], v[134:135], 1.0 op_sel_hi:[1,0]
    v_rcp_f32 v132, v132
    v_rcp_f32 v133, v133
    s_waitcnt lgkmcnt(4)
    v_min_u32 v28, v28, v29
    v_min3_u32 v28, v28, v30, v31
    v_cmp_gt_u32 vcc, 1, v28
    s_nop 0
    s_cmp_eq_u64 vcc, 0
    s_cbranch_scc1 L_pd7
    s_mov_b32 s96, 300000
L_pl7:
    s_sleep 1
    ds_read_b128 v[28:31], v27 offset:32
    s_waitcnt lgkmcnt(0)
    v_min_u32 v28, v28, v29
    v_min3_u32 v28, v28, v30, v31
    v_cmp_gt_u32 vcc, 1, v28
    s_sub_u32 s96, s96, 1
    s_cmp_eq_u32 s96, 0
    s_cbranch_scc1 L_pd7
    s_cmp_eq_u64 vcc, 0
    s_cbranch_scc0 L_pl7
L_pd7:
    v_mfma_f32_32x32x16_bf16 v[64:79], v[104:107], a[20:23], v[64:79]
    ds_read_b64_tr_b16 v[120:121], v21 offset:14336
    ds_read_b64_tr_b16 v[122:123], v21 offset:14848
    v_rcp_f32 v134, v134
    v_rcp_f32 v135, v135
    v_pk_mul_f32 v[36:37], v[132:133], v[36:37]
    v_mfma_f32_32x32x16_bf16 v[80:95], v[108:111], a[20:23], v[80:95]
    ds_read_b64_tr_b16 v[124:125], v22 offset:14336
    ds_read_b64_tr_b16 v[126:127], v22 offset:14848
    v_pk_mul_f32 v[38:39], v[134:135], v[38:39]
    v_cvt_pk_bf16_f32 v34, v36, v37
    v_cvt_pk_bf16_f32 v35, v38, v39
    buffer_store_dwordx4 v[32:35], v7, s[16:19], s58 offen offset:0 sc1
    s_waitcnt lgkmcnt(6)
    v_mfma_f32_32x32x16_bf16 v[64:79], v[112:115], a[24:27], v[64:79]
    ds_read_b64_tr_b16 v[96:97], v21 offset:16384
    ds_read_b64_tr_b16 v[98:99], v21 offset:16896
    v_pk_mul_f32 v[128:129], v[40:41], v[40:41]
    v_pk_mul_f32 v[130:131], v[42:43], v[42:43]
    v_pk_fma_f32 v[128:129], v[128:129], s[66:67], s[66:67] op_sel:[0,0,1] op_sel_hi:[1,0,1]
    v_pk_fma_f32 v[130:131], v[130:131], s[66:67], s[66:67] op_sel:[0,0,1] op_sel_hi:[1,0,1]
    v_pk_mul_f32 v[128:129], v[128:129], v[40:41]
    s_add_u32 m0, s51, 0
    s_nop 0
    buffer_load_dwordx4 v9, s[12:15], s23 offen offset:0 lds
    s_waitcnt lgkmcnt(6)
    v_mfma_f32_32x32x16_bf16 v[80:95], v[116:119], a[24:27], v[80:95]
    ds_read_b64_tr_b16 v[100:101], v22 offset:16384
    ds_read_b64_tr_b16 v[102:103], v22 offset:16896
    v_pk_mul_f32 v[130:131], v[130:131], v[42:43]
    v_exp_f32 v128, v128
    v_exp_f32 v129, v129
    s_waitcnt lgkmcnt(6)
    v_mfma_f32_32x32x16_bf16 v[64:79], v[120:123], a[28:31], v[64:79]
    ds_read_b64_tr_b16 v[104:105], v21 offset:18432
    ds_read_b64_tr_b16 v[106:107], v21 offset:18944
    v_exp_f32 v130, v130
    v_exp_f32 v131, v131
    v_pk_add_f32 v[128:129], v[128:129], 1.0 op_sel_hi:[1,0]
    s_waitcnt lgkmcnt(6)
    v_mfma_f32_32x32x16_bf16 v[80:95], v[124:127], a[28:31], v[80:95]
    ds_read_b64_tr_b16 v[108:109], v22 offset:18432
    ds_read_b64_tr_b16 v[110:111], v22 offset:18944
    v_pk_add_f32 v[130:131], v[130:131], 1.0 op_sel_hi:[1,0]
    v_rcp_f32 v128, v128
    v_rcp_f32 v129, v129
    buffer_load_dwordx4 v10, s[12:15], s23 offen offset:1024 lds
    s_waitcnt lgkmcnt(6)
    v_mfma_f32_32x32x16_bf16 v[64:79], v[96:99], a[32:35], v[64:79]
    ds_read_b64_tr_b16 v[112:113], v21 offset:20480
    ds_read_b64_tr_b16 v[114:115], v21 offset:20992
    v_rcp_f32 v130, v130
    v_rcp_f32 v131, v131
    s_waitcnt lgkmcnt(6)
    v_mfma_f32_32x32x16_bf16 v[80:95], v[100:103], a[32:35], v[80:95]
    ds_read_b64_tr_b16 v[116:117], v22 offset:20480
    ds_read_b64_tr_b16 v[118:119], v22 offset:20992
    v_pk_mul_f32 v[40:41], v[128:129], v[40:41]
    v_pk_mul_f32 v[42:43], v[130:131], v[42:43]
    v_cvt_pk_bf16_f32 v40, v40, v41
    v_cvt_pk_bf16_f32 v41, v42, v43
    v_pk_mul_f32 v[132:133], v[44:45], v[44:45]
    s_waitcnt lgkmcnt(6)
    v_mfma_f32_32x32x16_bf16 v[64:79], v[104:107], a[36:39], v[64:79]
    ds_read_b64_tr_b16 v[120:121], v21 offset:22528
    ds_read_b64_tr_b16 v[122:123], v21 offset:23040
    v_pk_mul_f32 v[134:135], v[46:47], v[46:47]
    v_pk_fma_f32 v[132:133], v[132:133], s[66:67], s[66:67] op_sel:[0,0,1] op_sel_hi:[1,0,1]
    v_pk_fma_f32 v[134:135], v[134:135], s[66:67], s[66:67] op_sel:[0,0,1] op_sel_hi:[1,0,1]
    v_pk_mul_f32 v[132:133], v[132:133], v[44:45]
    v_pk_mul_f32 v[134:135], v[134:135], v[46:47]
    s_add_u32 m0, s51, 8192
    s_nop 0
    buffer_load_dwordx4 v9, s[12:15], s24 offen offset:0 lds
    s_waitcnt lgkmcnt(6)
    v_mfma_f32_32x32x16_bf16 v[80:95], v[108:111], a[36:39], v[80:95]
    ds_read_b64_tr_b16 v[124:125], v22 offset:22528
    ds_read_b64_tr_b16 v[126:127], v22 offset:23040
    v_exp_f32 v132, v132
    v_exp_f32 v133, v133
    s_waitcnt lgkmcnt(6)
    v_mfma_f32_32x32x16_bf16 v[64:79], v[112:115], a[40:43], v[64:79]
    ds_read_b64_tr_b16 v[96:97], v21 offset:24576
    ds_read_b64_tr_b16 v[98:99], v21 offset:25088
    v_exp_f32 v134, v134
    v_exp_f32 v135, v135
    v_pk_add_f32 v[132:133], v[132:133], 1.0 op_sel_hi:[1,0]
    s_waitcnt lgkmcnt(6)
    v_mfma_f32_32x32x16_bf16 v[80:95], v[116:119], a[40:43], v[80:95]
    ds_read_b64_tr_b16 v[100:101], v22 offset:24576
    ds_read_b64_tr_b16 v[102:103], v22 offset:25088
    v_pk_add_f32 v[134:135], v[134:135], 1.0 op_sel_hi:[1,0]
    v_rcp_f32 v132, v132
    v_rcp_f32 v133, v133
    buffer_load_dwordx4 v10, s[12:15], s24 offen offset:1024 lds
    s_waitcnt lgkmcnt(6)
    v_mfma_f32_32x32x16_bf16 v[64:79], v[120:123], a[44:47], v[64:79]
    ds_read_b64_tr_b16 v[104:105], v21 offset:26624
    ds_read_b64_tr_b16 v[106:107], v21 offset:27136
    v_rcp_f32 v134, v134
    v_rcp_f32 v135, v135
    v_pk_mul_f32 v[44:45], v[132:133], v[44:45]
    s_waitcnt lgkmcnt(6)
    v_mfma_f32_32x32x16_bf16 v[80:95], v[124:127], a[44:47], v[80:95]
    ds_read_b64_tr_b16 v[108:109], v22 offset:26624
    ds_read_b64_tr_b16 v[110:111], v22 offset:27136
    v_pk_mul_f32 v[46:47], v[134:135], v[46:47]
    v_cvt_pk_bf16_f32 v42, v44, v45
    v_cvt_pk_bf16_f32 v43, v46, v47
    buffer_store_dwordx4 v[40:43], v7, s[16:19], s58 offen offset:1024 sc1
    s_waitcnt lgkmcnt(6)
    v_mfma_f32_32x32x16_bf16 v[64:79], v[96:99], a[48:51], v[64:79]
    ds_read_b64_tr_b16 v[112:113], v21 offset:28672
    ds_read_b64_tr_b16 v[114:115], v21 offset:29184
    v_pk_mul_f32 v[136:137], v[48:49], v[48:49]
    v_pk_mul_f32 v[138:139], v[50:51], v[50:51]
    v_pk_fma_f32 v[136:137], v[136:137], s[66:67], s[66:67] op_sel:[0,0,1] op_sel_hi:[1,0,1]
    v_pk_fma_f32 v[138:139], v[138:139], s[66:67], s[66:67] op_sel:[0,0,1] op_sel_hi:[1,0,1]
    v_pk_mul_f32 v[136:137], v[136:137], v[48:49]
    s_add_u32 m0, s51, 16384
    s_nop 0
    buffer_load_dwordx4 v9, s[12:15], s25 offen offset:0 lds
    s_waitcnt lgkmcnt(6)
    v_mfma_f32_32x32x16_bf16 v[80:95], v[100:103], a[48:51], v[80:95]
    ds_read_b64_tr_b16 v[116:117], v22 offset:28672
    ds_read_b64_tr_b16 v[118:119], v22 offset:29184
    v_pk_mul_f32 v[138:139], v[138:139], v[50:51]
    v_exp_f32 v136, v136
    v_exp_f32 v137, v137
    s_waitcnt lgkmcnt(6)
    v_mfma_f32_32x32x16_bf16 v[64:79], v[104:107], a[52:55], v[64:79]
    ds_read_b64_tr_b16 v[120:121], v21 offset:30720
    ds_read_b64_tr_b16 v[122:123], v21 offset:31232
    v_exp_f32 v138, v138
    v_exp_f32 v139, v139
    v_pk_add_f32 v[136:137], v[136:137], 1.0 op_sel_hi:[1,0]
    s_waitcnt lgkmcnt(6)
    v_mfma_f32_32x32x16_bf16 v[80:95], v[108:111], a[52:55], v[80:95]
    ds_read_b64_tr_b16 v[124:125], v22 offset:30720
    ds_read_b64_tr_b16 v[126:127], v22 offset:31232
    v_pk_add_f32 v[138:139], v[138:139], 1.0 op_sel_hi:[1,0]
    v_rcp_f32 v136, v136
    v_rcp_f32 v137, v137
    buffer_load_dwordx4 v10, s[12:15], s25 offen offset:1024 lds
    s_waitcnt lgkmcnt(6)
    v_mfma_f32_32x32x16_bf16 v[64:79], v[112:115], a[56:59], v[64:79]
    ds_read_b64_tr_b16 v[96:97], v21 offset:32768
    ds_read_b64_tr_b16 v[98:99], v21 offset:33280
    v_rcp_f32 v138, v138
    v_rcp_f32 v139, v139
    s_waitcnt lgkmcnt(6)
    v_mfma_f32_32x32x16_bf16 v[80:95], v[116:119], a[56:59], v[80:95]
    ds_read_b64_tr_b16 v[100:101], v22 offset:32768
    ds_read_b64_tr_b16 v[102:103], v22 offset:33280
    v_pk_mul_f32 v[48:49], v[136:137], v[48:49]
    v_pk_mul_f32 v[50:51], v[138:139], v[50:51]
    v_cvt_pk_bf16_f32 v48, v48, v49
    v_cvt_pk_bf16_f32 v49, v50, v51
    v_pk_mul_f32 v[140:141], v[52:53], v[52:53]
    s_waitcnt lgkmcnt(6)
    v_mfma_f32_32x32x16_bf16 v[64:79], v[120:123], a[60:63], v[64:79]
    ds_read_b64_tr_b16 v[104:105], v21 offset:34816
    ds_read_b64_tr_b16 v[106:107], v21 offset:35328
    v_pk_mul_f32 v[142:143], v[54:55], v[54:55]
    v_pk_fma_f32 v[140:141], v[140:141], s[66:67], s[66:67] op_sel:[0,0,1] op_sel_hi:[1,0,1]
    v_pk_fma_f32 v[142:143], v[142:143], s[66:67], s[66:67] op_sel:[0,0,1] op_sel_hi:[1,0,1]
    v_pk_mul_f32 v[140:141], v[140:141], v[52:53]
    v_pk_mul_f32 v[142:143], v[142:143], v[54:55]
    s_add_u32 m0, s51, 24576
    s_nop 0
    buffer_load_dwordx4 v9, s[12:15], s26 offen offset:0 lds
    s_waitcnt lgkmcnt(6)
    v_mfma_f32_32x32x16_bf16 v[80:95], v[124:127], a[60:63], v[80:95]
    ds_read_b64_tr_b16 v[108:109], v22 offset:34816
    ds_read_b64_tr_b16 v[110:111], v22 offset:35328
    v_exp_f32 v140, v140
    v_exp_f32 v141, v141
    s_waitcnt lgkmcnt(6)
    v_mfma_f32_32x32x16_bf16 v[64:79], v[96:99], a[64:67], v[64:79]
    ds_read_b64_tr_b16 v[112:113], v21 offset:36864
    ds_read_b64_tr_b16 v[114:115], v21 offset:37376
    v_exp_f32 v142, v142
    v_exp_f32 v143, v143
    v_pk_add_f32 v[140:141], v[140:141], 1.0 op_sel_hi:[1,0]
    s_waitcnt lgkmcnt(6)
    v_mfma_f32_32x32x16_bf16 v[80:95], v[100:103], a[64:67], v[80:95]
    ds_read_b64_tr_b16 v[116:117], v22 offset:36864
    ds_read_b64_tr_b16 v[118:119], v22 offset:37376
    v_pk_add_f32 v[142:143], v[142:143], 1.0 op_sel_hi:[1,0]
    v_rcp_f32 v140, v140
    v_rcp_f32 v141, v141
    s_waitcnt lgkmcnt(6)
    v_mfma_f32_32x32x16_bf16 v[64:79], v[104:107], a[68:71], v[64:79]
    ds_read_b64_tr_b16 v[120:121], v21 offset:38912
    ds_read_b64_tr_b16 v[122:123], v21 offset:39424
    v_rcp_f32 v142, v142
    v_rcp_f32 v143, v143
    v_pk_mul_f32 v[52:53], v[140:141], v[52:53]
    buffer_load_dwordx4 v10, s[12:15], s26 offen offset:1024 lds
    s_waitcnt lgkmcnt(6)
    v_mfma_f32_32x32x16_bf16 v[80:95], v[108:111], a[68:71], v[80:95]
    ds_read_b64_tr_b16 v[124:125], v22 offset:38912
    ds_read_b64_tr_b16 v[126:127], v22 offset:39424
    v_pk_mul_f32 v[54:55], v[142:143], v[54:55]
    v_cvt_pk_bf16_f32 v50, v52, v53
    v_cvt_pk_bf16_f32 v51, v54, v55
    buffer_store_dwordx4 v[48:51], v7, s[16:19], s58 offen offset:2048 sc1
    s_waitcnt lgkmcnt(6)
    v_mfma_f32_32x32x16_bf16 v[64:79], v[112:115], a[72:75], v[64:79]
    ds_read_b64_tr_b16 v[96:97], v21 offset:40960
    ds_read_b64_tr_b16 v[98:99], v21 offset:41472
    v_pk_mul_f32 v[136:137], v[56:57], v[56:57]
    v_pk_mul_f32 v[138:139], v[58:59], v[58:59]
    v_pk_fma_f32 v[136:137], v[136:137], s[66:67], s[66:67] op_sel:[0,0,1] op_sel_hi:[1,0,1]
    v_pk_fma_f32 v[138:139], v[138:139], s[66:67], s[66:67] op_sel:[0,0,1] op_sel_hi:[1,0,1]
    v_pk_mul_f32 v[136:137], v[136:137], v[56:57]
    s_waitcnt lgkmcnt(6)
    v_mfma_f32_32x32x16_bf16 v[80:95], v[116:119], a[72:75], v[80:95]
    ds_read_b64_tr_b16 v[100:101], v22 offset:40960
    ds_read_b64_tr_b16 v[102:103], v22 offset:41472
    v_pk_mul_f32 v[138:139], v[138:139], v[58:59]
    v_exp_f32 v136, v136
    v_exp_f32 v137, v137
    s_add_u32 m0, s51, 32768
    s_nop 0
    buffer_load_dwordx4 v11, s[12:15], s20 offen offset:0 lds
    s_waitcnt lgkmcnt(6)
    v_mfma_f32_32x32x16_bf16 v[64:79], v[120:123], a[76:79], v[64:79]
    ds_read_b64_tr_b16 v[104:105], v21 offset:43008
    ds_read_b64_tr_b16 v[106:107], v21 offset:43520
    v_exp_f32 v138, v138
    v_exp_f32 v139, v139
    v_pk_add_f32 v[136:137], v[136:137], 1.0 op_sel_hi:[1,0]
    s_waitcnt lgkmcnt(6)
    v_mfma_f32_32x32x16_bf16 v[80:95], v[124:127], a[76:79], v[80:95]
    ds_read_b64_tr_b16 v[108:109], v22 offset:43008
    ds_read_b64_tr_b16 v[110:111], v22 offset:43520
    v_pk_add_f32 v[138:139], v[138:139], 1.0 op_sel_hi:[1,0]
    v_rcp_f32 v136, v136
    v_rcp_f32 v137, v137
    s_waitcnt lgkmcnt(6)
    v_mfma_f32_32x32x16_bf16 v[64:79], v[96:99], a[80:83], v[64:79]
    ds_read_b64_tr_b16 v[112:113], v21 offset:45056
    ds_read_b64_tr_b16 v[114:115], v21 offset:45568
    v_rcp_f32 v138, v138
    v_rcp_f32 v139, v139
    buffer_load_dwordx4 v12, s[12:15], s20 offen offset:1024 lds
    s_waitcnt lgkmcnt(6)
    v_mfma_f32_32x32x16_bf16 v[80:95], v[100:103], a[80:83], v[80:95]
    ds_read_b64_tr_b16 v[116:117], v22 offset:45056
    ds_read_b64_tr_b16 v[118:119], v22 offset:45568
    v_pk_mul_f32 v[56:57], v[136:137], v[56:57]
    v_pk_mul_f32 v[58:59], v[138:139], v[58:59]
    v_cvt_pk_bf16_f32 v56, v56, v57
    v_cvt_pk_bf16_f32 v57, v58, v59
    v_pk_mul_f32 v[140:141], v[60:61], v[60:61]
    s_waitcnt lgkmcnt(6)
    v_mfma_f32_32x32x16_bf16 v[64:79], v[104:107], a[84:87], v[64:79]
    ds_read_b64_tr_b16 v[120:121], v21 offset:47104
    ds_read_b64_tr_b16 v[122:123], v21 offset:47616
    v_pk_mul_f32 v[142:143], v[62:63], v[62:63]
    v_pk_fma_f32 v[140:141], v[140:141], s[66:67], s[66:67] op_sel:[0,0,1] op_sel_hi:[1,0,1]
    v_pk_fma_f32 v[142:143], v[142:143], s[66:67], s[66:67] op_sel:[0,0,1] op_sel_hi:[1,0,1]
    v_pk_mul_f32 v[140:141], v[140:141], v[60:61]
    v_pk_mul_f32 v[142:143], v[142:143], v[62:63]
    s_waitcnt lgkmcnt(6)
    v_mfma_f32_32x32x16_bf16 v[80:95], v[108:111], a[84:87], v[80:95]
    ds_read_b64_tr_b16 v[124:125], v22 offset:47104
    ds_read_b64_tr_b16 v[126:127], v22 offset:47616
    v_exp_f32 v140, v140
    v_exp_f32 v141, v141
    s_add_u32 m0, s51, 40960
    s_nop 0
    buffer_load_dwordx4 v11, s[12:15], s21 offen offset:0 lds
    s_waitcnt vmcnt(8)
    s_mov_b64 exec, 1
    buffer_store_dword v24, off, s[16:19], s61 sc1
    s_mov_b64 exec, -1
    s_add_u32 s61, s61, 0x20000
    s_waitcnt lgkmcnt(6)
    v_mfma_f32_32x32x16_bf16 v[64:79], v[112:115], a[88:91], v[64:79]
    ds_read_b64_tr_b16 v[96:97], v21 offset:49152
    ds_read_b64_tr_b16 v[98:99], v21 offset:49664
    v_exp_f32 v142, v142
    v_exp_f32 v143, v143
    v_pk_add_f32 v[140:141], v[140:141], 1.0 op_sel_hi:[1,0]
    s_waitcnt lgkmcnt(6)
    v_mfma_f32_32x32x16_bf16 v[80:95], v[116:119], a[88:91], v[80:95]
    ds_read_b64_tr_b16 v[100:101], v22 offset:49152
    ds_read_b64_tr_b16 v[102:103], v22 offset:49664
    v_pk_add_f32 v[142:143], v[142:143], 1.0 op_sel_hi:[1,0]
    v_rcp_f32 v140, v140
    v_rcp_f32 v141, v141
    s_waitcnt lgkmcnt(6)
    v_mfma_f32_32x32x16_bf16 v[64:79], v[120:123], a[92:95], v[64:79]
    ds_read_b64_tr_b16 v[104:105], v21 offset:51200
    ds_read_b64_tr_b16 v[106:107], v21 offset:51712
    v_rcp_f32 v142, v142
    v_rcp_f32 v143, v143
    v_pk_mul_f32 v[60:61], v[140:141], v[60:61]
    buffer_load_dwordx4 v12, s[12:15], s21 offen offset:1024 lds
    s_waitcnt lgkmcnt(6)
    v_mfma_f32_32x32x16_bf16 v[80:95], v[124:127], a[92:95], v[80:95]
    ds_read_b64_tr_b16 v[108:109], v22 offset:51200
    ds_read_b64_tr_b16 v[110:111], v22 offset:51712
    v_pk_mul_f32 v[62:63], v[142:143], v[62:63]
    v_cvt_pk_bf16_f32 v58, v60, v61
    v_cvt_pk_bf16_f32 v59, v62, v63
    buffer_store_dwordx4 v[56:59], v7, s[16:19], s58 offen offset:3072 sc1
    s_waitcnt lgkmcnt(6)
    v_mfma_f32_32x32x16_bf16 v[64:79], v[96:99], a[96:99], v[64:79]
    ds_read_b64_tr_b16 v[112:113], v21 offset:53248
    ds_read_b64_tr_b16 v[114:115], v21 offset:53760
    s_waitcnt lgkmcnt(6)
    v_mfma_f32_32x32x16_bf16 v[80:95], v[100:103], a[96:99], v[80:95]
    ds_read_b64_tr_b16 v[116:117], v22 offset:53248
    ds_read_b64_tr_b16 v[118:119], v22 offset:53760
    s_add_u32 m0, s51, 49152
    s_nop 0
    buffer_load_dwordx4 v11, s[12:15], s22 offen offset:0 lds
    s_waitcnt lgkmcnt(6)
    v_mfma_f32_32x32x16_bf16 v[64:79], v[104:107], a[100:103], v[64:79]
    ds_read_b64_tr_b16 v[120:121], v21 offset:55296
    ds_read_b64_tr_b16 v[122:123], v21 offset:55808
    s_waitcnt lgkmcnt(6)
    v_mfma_f32_32x32x16_bf16 v[80:95], v[108:111], a[100:103], v[80:95]
    ds_read_b64_tr_b16 v[124:125], v22 offset:55296
    ds_read_b64_tr_b16 v[126:127], v22 offset:55808
    s_waitcnt lgkmcnt(6)
    v_mfma_f32_32x32x16_bf16 v[64:79], v[112:115], a[104:107], v[64:79]
    buffer_load_dwordx4 v12, s[12:15], s22 offen offset:1024 lds
    s_waitcnt lgkmcnt(4)
    v_mfma_f32_32x32x16_bf16 v[80:95], v[116:119], a[104:107], v[80:95]
    s_waitcnt lgkmcnt(2)
    v_mfma_f32_32x32x16_bf16 v[64:79], v[120:123], a[108:111], v[64:79]
    s_waitcnt lgkmcnt(0)
    v_mfma_f32_32x32x16_bf16 v[80:95], v[124:127], a[108:111], v[80:95]
    v_mov_b32 v28, 2
    ds_write_b32 v26, v28 offset:32
    ds_read_b128 v[28:31], v27 offset:32
    s_nop 6
    v_pk_mul_f32 v[128:129], v[64:65], v[64:65]
    v_pk_mul_f32 v[130:131], v[66:67], v[66:67]
    v_pk_fma_f32 v[128:129], v[128:129], s[66:67], s[66:67] op_sel:[0,0,1] op_sel_hi:[1,0,1]
    v_pk_fma_f32 v[130:131], v[130:131], s[66:67], s[66:67] op_sel:[0,0,1] op_sel_hi:[1,0,1]
    v_pk_mul_f32 v[128:129], v[128:129], v[64:65]
    v_pk_mul_f32 v[130:131], v[130:131], v[66:67]
    v_exp_f32 v128, v128
    v_exp_f32 v129, v129
    v_exp_f32 v130, v130
    v_exp_f32 v131, v131
    v_pk_add_f32 v[128:129], v[128:129], 1.0 op_sel_hi:[1,0]
    v_pk_add_f32 v[130:131], v[130:131], 1.0 op_sel_hi:[1,0]
    v_rcp_f32 v128, v128
    v_rcp_f32 v129, v129
    v_rcp_f32 v130, v130
    v_rcp_f32 v131, v131
    s_waitcnt lgkmcnt(0)
    v_min_u32 v28, v28, v29
    v_min3_u32 v28, v28, v30, v31
    v_cmp_gt_u32 vcc, 2, v28
    s_nop 0
    s_cmp_eq_u64 vcc, 0
    s_cbranch_scc1 L_pd8
    s_mov_b32 s96, 300000
L_pl8:
    s_sleep 1
    ds_read_b128 v[28:31], v27 offset:32
    s_waitcnt lgkmcnt(0)
    v_min_u32 v28, v28, v29
    v_min3_u32 v28, v28, v30, v31
    v_cmp_gt_u32 vcc, 2, v28
    s_sub_u32 s96, s96, 1
    s_cmp_eq_u32 s96, 0
    s_cbranch_scc1 L_pd8
    s_cmp_eq_u64 vcc, 0
    s_cbranch_scc0 L_pl8
L_pd8:
    v_pk_mul_f32 v[64:65], v[128:129], v[64:65]
    s_add_u32 m0, s51, 57344
    s_nop 0
    buffer_load_dwordx4 v11, s[12:15], s23 offen offset:0 lds
    v_pk_mul_f32 v[66:67], v[130:131], v[66:67]
    v_cvt_pk_bf16_f32 v64, v64, v65
    v_cvt_pk_bf16_f32 v65, v66, v67
    v_pk_mul_f32 v[132:133], v[68:69], v[68:69]
    buffer_load_dwordx4 v12, s[12:15], s23 offen offset:1024 lds
    v_pk_mul_f32 v[134:135], v[70:71], v[70:71]
    v_pk_fma_f32 v[132:133], v[132:133], s[66:67], s[66:67] op_sel:[0,0,1] op_sel_hi:[1,0,1]
    v_pk_fma_f32 v[134:135], v[134:135], s[66:67], s[66:67] op_sel:[0,0,1] op_sel_hi:[1,0,1]
    v_pk_mul_f32 v[132:133], v[132:133], v[68:69]
    s_add_u32 m0, s51, 65536
    s_nop 0
    buffer_load_dwordx4 v11, s[12:15], s24 offen offset:0 lds
    v_pk_mul_f32 v[134:135], v[134:135], v[70:71]
    v_exp_f32 v132, v132
    v_exp_f32 v133, v133
    v_exp_f32 v134, v134
    buffer_load_dwordx4 v12, s[12:15], s24 offen offset:1024 lds
    v_exp_f32 v135, v135
    v_pk_add_f32 v[132:133], v[132:133], 1.0 op_sel_hi:[1,0]
    v_pk_add_f32 v[134:135], v[134:135], 1.0 op_sel_hi:[1,0]
    v_rcp_f32 v132, v132
    s_add_u32 m0, s51, 73728
    s_nop 0
    buffer_load_dwordx4 v11, s[12:15], s25 offen offset:0 lds
    v_rcp_f32 v133, v133
    v_rcp_f32 v134, v134
    v_rcp_f32 v135, v135
    v_pk_mul_f32 v[68:69], v[132:133], v[68:69]
    buffer_load_dwordx4 v12, s[12:15], s25 offen offset:1024 lds
    v_pk_mul_f32 v[70:71], v[134:135], v[70:71]
    v_cvt_pk_bf16_f32 v66, v68, v69
    v_cvt_pk_bf16_f32 v67, v70, v71
    buffer_store_dwordx4 v[64:67], v7, s[16:19], s59 offen offset:0 sc1
    s_add_u32 m0, s51, 81920
    s_nop 0
    buffer_load_dwordx4 v11, s[12:15], s26 offen offset:0 lds
    v_pk_mul_f32 v[128:129], v[72:73], v[72:73]
    v_pk_mul_f32 v[130:131], v[74:75], v[74:75]
    v_pk_fma_f32 v[128:129], v[128:129], s[66:67], s[66:67] op_sel:[0,0,1] op_sel_hi:[1,0,1]
    v_pk_fma_f32 v[130:131], v[130:131], s[66:67], s[66:67] op_sel:[0,0,1] op_sel_hi:[1,0,1]
    buffer_load_dwordx4 v12, s[12:15], s26 offen offset:1024 lds
    v_pk_mul_f32 v[128:129], v[128:129], v[72:73]
    v_pk_mul_f32 v[130:131], v[130:131], v[74:75]
    v_exp_f32 v128, v128
    v_exp_f32 v129, v129
    s_waitcnt vmcnt(11)
    s_mov_b64 exec, 1
    buffer_store_dword v24, off, s[16:19], s61 sc1
    s_mov_b64 exec, -1
    s_add_u32 s61, s61, 0x20000
    v_exp_f32 v130, v130
    v_exp_f32 v131, v131
    v_pk_add_f32 v[128:129], v[128:129], 1.0 op_sel_hi:[1,0]
    v_pk_add_f32 v[130:131], v[130:131], 1.0 op_sel_hi:[1,0]
    v_rcp_f32 v128, v128
    v_rcp_f32 v129, v129
    v_rcp_f32 v130, v130
    v_rcp_f32 v131, v131
    v_pk_mul_f32 v[72:73], v[128:129], v[72:73]
    v_pk_mul_f32 v[74:75], v[130:131], v[74:75]
    v_cvt_pk_bf16_f32 v72, v72, v73
    v_cvt_pk_bf16_f32 v73, v74, v75
    v_pk_mul_f32 v[132:133], v[76:77], v[76:77]
    v_pk_mul_f32 v[134:135], v[78:79], v[78:79]
    v_pk_fma_f32 v[132:133], v[132:133], s[66:67], s[66:67] op_sel:[0,0,1] op_sel_hi:[1,0,1]
    v_pk_fma_f32 v[134:135], v[134:135], s[66:67], s[66:67] op_sel:[0,0,1] op_sel_hi:[1,0,1]
    v_pk_mul_f32 v[132:133], v[132:133], v[76:77]
    v_pk_mul_f32 v[134:135], v[134:135], v[78:79]
    v_exp_f32 v132, v132
    v_exp_f32 v133, v133
    v_exp_f32 v134, v134
    v_exp_f32 v135, v135
    v_pk_add_f32 v[132:133], v[132:133], 1.0 op_sel_hi:[1,0]
    v_pk_add_f32 v[134:135], v[134:135], 1.0 op_sel_hi:[1,0]
    v_rcp_f32 v132, v132
    v_rcp_f32 v133, v133
    v_rcp_f32 v134, v134
    v_rcp_f32 v135, v135
    v_pk_mul_f32 v[76:77], v[132:133], v[76:77]
    v_pk_mul_f32 v[78:79], v[134:135], v[78:79]
    v_cvt_pk_bf16_f32 v74, v76, v77
    v_cvt_pk_bf16_f32 v75, v78, v79
    buffer_store_dwordx4 v[72:75], v7, s[16:19], s59 offen offset:1024 sc1
    v_pk_mul_f32 v[136:137], v[80:81], v[80:81]
    v_pk_mul_f32 v[138:139], v[82:83], v[82:83]
    v_pk_fma_f32 v[136:137], v[136:137], s[66:67], s[66:67] op_sel:[0,0,1] op_sel_hi:[1,0,1]
    v_pk_fma_f32 v[138:139], v[138:139], s[66:67], s[66:67] op_sel:[0,0,1] op_sel_hi:[1,0,1]
    v_pk_mul_f32 v[136:137], v[136:137], v[80:81]
    v_pk_mul_f32 v[138:139], v[138:139], v[82:83]
    v_exp_f32 v136, v136
    v_exp_f32 v137, v137
    v_exp_f32 v138, v138
    v_exp_f32 v139, v139
    v_pk_add_f32 v[136:137], v[136:137], 1.0 op_sel_hi:[1,0]
    v_pk_add_f32 v[138:139], v[138:139], 1.0 op_sel_hi:[1,0]
    v_rcp_f32 v136, v136
    v_rcp_f32 v137, v137
    v_rcp_f32 v138, v138
    v_rcp_f32 v139, v139
    v_pk_mul_f32 v[80:81], v[136:137], v[80:81]
    v_pk_mul_f32 v[82:83], v[138:139], v[82:83]
    v_cvt_pk_bf16_f32 v80, v80, v81
    v_cvt_pk_bf16_f32 v81, v82, v83
    v_pk_mul_f32 v[140:141], v[84:85], v[84:85]
    v_pk_mul_f32 v[142:143], v[86:87], v[86:87]
    v_pk_fma_f32 v[140:141], v[140:141], s[66:67], s[66:67] op_sel:[0,0,1] op_sel_hi:[1,0,1]
    v_pk_fma_f32 v[142:143], v[142:143], s[66:67], s[66:67] op_sel:[0,0,1] op_sel_hi:[1,0,1]
    v_pk_mul_f32 v[140:141], v[140:141], v[84:85]
    v_pk_mul_f32 v[142:143], v[142:143], v[86:87]
    v_exp_f32 v140, v140
    v_exp_f32 v141, v141
    v_exp_f32 v142, v142
    v_exp_f32 v143, v143
    v_pk_add_f32 v[140:141], v[140:141], 1.0 op_sel_hi:[1,0]
    v_pk_add_f32 v[142:143], v[142:143], 1.0 op_sel_hi:[1,0]
    buffer_load_dword v6, v25, s[16:19], s65 offen sc1
    v_rcp_f32 v140, v140
    v_rcp_f32 v141, v141
    v_rcp_f32 v142, v142
    v_rcp_f32 v143, v143
    v_pk_mul_f32 v[84:85], v[140:141], v[84:85]
    v_pk_mul_f32 v[86:87], v[142:143], v[86:87]
    v_cvt_pk_bf16_f32 v82, v84, v85
    v_cvt_pk_bf16_f32 v83, v86, v87
    buffer_store_dwordx4 v[80:83], v7, s[16:19], s59 offen offset:2048 sc1
    v_pk_mul_f32 v[136:137], v[88:89], v[88:89]
    v_pk_mul_f32 v[138:139], v[90:91], v[90:91]
    v_pk_fma_f32 v[136:137], v[136:137], s[66:67], s[66:67] op_sel:[0,0,1] op_sel_hi:[1,0,1]
    v_pk_fma_f32 v[138:139], v[138:139], s[66:67], s[66:67] op_sel:[0,0,1] op_sel_hi:[1,0,1]
    v_pk_mul_f32 v[136:137], v[136:137], v[88:89]
    v_pk_mul_f32 v[138:139], v[138:139], v[90:91]
    v_exp_f32 v136, v136
    v_exp_f32 v137, v137
    v_exp_f32 v138, v138
    v_exp_f32 v139, v139
    v_pk_add_f32 v[136:137], v[136:137], 1.0 op_sel_hi:[1,0]
    v_pk_add_f32 v[138:139], v[138:139], 1.0 op_sel_hi:[1,0]
    v_rcp_f32 v136, v136
    v_rcp_f32 v137, v137
    v_rcp_f32 v138, v138
    v_rcp_f32 v139, v139
    v_pk_mul_f32 v[88:89], v[136:137], v[88:89]
    v_pk_mul_f32 v[90:91], v[138:139], v[90:91]
    v_cvt_pk_bf16_f32 v88, v88, v89
    v_cvt_pk_bf16_f32 v89, v90, v91
    v_pk_mul_f32 v[140:141], v[92:93], v[92:93]
    v_pk_mul_f32 v[142:143], v[94:95], v[94:95]
    v_pk_fma_f32 v[140:141], v[140:141], s[66:67], s[66:67] op_sel:[0,0,1] op_sel_hi:[1,0,1]
    v_pk_fma_f32 v[142:143], v[142:143], s[66:67], s[66:67] op_sel:[0,0,1] op_sel_hi:[1,0,1]
    v_pk_mul_f32 v[140:141], v[140:141], v[92:93]
    v_pk_mul_f32 v[142:143], v[142:143], v[94:95]
    v_exp_f32 v140, v140
    v_exp_f32 v141, v141
    v_exp_f32 v142, v142
    v_exp_f32 v143, v143
    v_pk_add_f32 v[140:141], v[140:141], 1.0 op_sel_hi:[1,0]
    v_pk_add_f32 v[142:143], v[142:143], 1.0 op_sel_hi:[1,0]
    v_rcp_f32 v140, v140
    v_rcp_f32 v141, v141
    v_rcp_f32 v142, v142
    v_rcp_f32 v143, v143
    v_pk_mul_f32 v[92:93], v[140:141], v[92:93]
    v_pk_mul_f32 v[94:95], v[142:143], v[94:95]
    v_cvt_pk_bf16_f32 v90, v92, v93
    v_cvt_pk_bf16_f32 v91, v94, v95
    buffer_store_dwordx4 v[88:91], v7, s[16:19], s59 offen offset:3072 sc1
    s_waitcnt vmcnt(2)
    v_subrev_u32 v6, s73, v6
    v_cmp_le_u32 vcc, 1, v6
    s_nop 0
    s_cmp_eq_u64 vcc, 0
    s_cbranch_scc1 L_pd9
    s_mov_b32 s96, 300000
L_pl9:
    s_sleep 10
    buffer_load_dword v6, v25, s[16:19], s65 offen sc1
    s_waitcnt vmcnt(0)
    v_subrev_u32 v6, s73, v6
    v_cmp_le_u32 vcc, 1, v6
    s_sub_u32 s96, s96, 1
    s_cmp_eq_u32 s96, 0
    s_cbranch_scc1 L_pd9
    s_cmp_eq_u64 vcc, 0
    s_cbranch_scc0 L_pl9
L_pd9:
    buffer_load_dwordx4 a[0:3], v13, s[16:19], s4 offen offset:0 sc1
    buffer_load_dwordx4 a[4:7], v15, s[16:19], s4 offen offset:0 sc1
    buffer_load_dwordx4 a[8:11], v13, s[16:19], s5 offen offset:0 sc1
    buffer_load_dwordx4 a[12:15], v15, s[16:19], s5 offen offset:0 sc1
    buffer_load_dwordx4 a[16:19], v13, s[16:19], s6 offen offset:0 sc1
    buffer_load_dwordx4 a[20:23], v15, s[16:19], s6 offen offset:0 sc1
    buffer_load_dwordx4 a[24:27], v13, s[16:19], s7 offen offset:0 sc1
    buffer_load_dwordx4 a[28:31], v15, s[16:19], s7 offen offset:0 sc1
    buffer_load_dwordx4 a[32:35], v13, s[16:19], s40 offen offset:0 sc1
    buffer_load_dwordx4 a[36:39], v15, s[16:19], s40 offen offset:0 sc1
    buffer_load_dwordx4 a[40:43], v13, s[16:19], s41 offen offset:0 sc1
    buffer_load_dwordx4 a[44:47], v15, s[16:19], s41 offen offset:0 sc1
    buffer_load_dwordx4 a[48:51], v13, s[16:19], s42 offen offset:0 sc1
    buffer_load_dwordx4 a[52:55], v15, s[16:19], s42 offen offset:0 sc1
    s_waitcnt vmcnt(14)
    buffer_load_dword v6, v25, s[16:19], s68 offen sc1
    s_mov_b64 exec, 1
    buffer_store_dword v24, off, s[16:19], s61 sc1
    s_mov_b64 exec, -1
    v_subrev_u32 v64, 122880, v17
    v_subrev_u32 v68, 65536, v17
    v_subrev_u32 v65, 122880, v18
    v_subrev_u32 v69, 65536, v18
    v_subrev_u32 v66, 122880, v19
    v_subrev_u32 v70, 65536, v19
    v_subrev_u32 v67, 122880, v20
    v_subrev_u32 v71, 65536, v20
    v_mov_b32 v28, 3
    ds_write_b32 v26, v28 offset:32
    ds_read_b128 v[28:31], v27 offset:32
    s_waitcnt lgkmcnt(0)
    v_min_u32 v28, v28, v29
    v_min3_u32 v28, v28, v30, v31
    v_cmp_gt_u32 vcc, 3, v28
    s_nop 0
    s_cmp_eq_u64 vcc, 0
    s_cbranch_scc1 L_pd10
    s_mov_b32 s96, 300000
L_pl10:
    s_sleep 1
    ds_read_b128 v[28:31], v27 offset:32
    s_waitcnt lgkmcnt(0)
    v_min_u32 v28, v28, v29
    v_min3_u32 v28, v28, v30, v31
    v_cmp_gt_u32 vcc, 3, v28
    s_sub_u32 s96, s96, 1
    s_cmp_eq_u32 s96, 0
    s_cbranch_scc1 L_pd10
    s_cmp_eq_u64 vcc, 0
    s_cbranch_scc0 L_pl10
L_pd10:
    ds_read_b64_tr_b16 v[96:97], v17 offset:0
    ds_read_b64_tr_b16 v[98:99], v17 offset:1024
    ds_read_b64_tr_b16 v[100:101], v18 offset:0
    ds_read_b64_tr_b16 v[102:103], v18 offset:1024
    ds_read_b64_tr_b16 v[104:105], v19 offset:0
    ds_read_b64_tr_b16 v[106:107], v19 offset:1024
    ds_read_b64_tr_b16 v[108:109], v20 offset:0
    ds_read_b64_tr_b16 v[110:111], v20 offset:1024
    ds_read_b64_tr_b16 v[112:113], v17 offset:8192
    ds_read_b64_tr_b16 v[114:115], v17 offset:9216
    ds_read_b64_tr_b16 v[116:117], v18 offset:8192
    ds_read_b64_tr_b16 v[118:119], v18 offset:9216
    ds_read_b64_tr_b16 v[120:121], v19 offset:8192
    ds_read_b64_tr_b16 v[122:123], v19 offset:9216
    ds_read_b64_tr_b16 v[124:125], v20 offset:8192
    ds_read_b64_tr_b16 v[126:127], v20 offset:9216
    s_waitcnt vmcnt(15) lgkmcnt(14)
    v_mfma_f32_16x16x32_bf16 v[32:35], v[96:99], a[0:3], 0
    ds_read_b64_tr_b16 v[128:129], v17 offset:16384
    s_waitcnt lgkmcnt(13)
    v_mfma_f32_16x16x32_bf16 v[36:39], v[100:103], a[0:3], 0
    ds_read_b64_tr_b16 v[130:131], v17 offset:17408
    s_waitcnt lgkmcnt(12)
    v_mfma_f32_16x16x32_bf16 v[40:43], v[104:107], a[0:3], 0
    ds_read_b64_tr_b16 v[132:133], v18 offset:16384
    s_waitcnt lgkmcnt(11)
    v_mfma_f32_16x16x32_bf16 v[44:47], v[108:111], a[0:3], 0
    ds_read_b64_tr_b16 v[134:135], v18 offset:17408
    s_waitcnt vmcnt(14)
    v_mfma_f32_16x16x32_bf16 v[48:51], v[96:99], a[4:7], 0
    ds_read_b64_tr_b16 v[136:137], v19 offset:16384
    v_mfma_f32_16x16x32_bf16 v[52:55], v[100:103], a[4:7], 0
    ds_read_b64_tr_b16 v[138:139], v19 offset:17408
    v_mfma_f32_16x16x32_bf16 v[56:59], v[104:107], a[4:7], 0
    ds_read_b64_tr_b16 v[140:141], v20 offset:16384
    v_mfma_f32_16x16x32_bf16 v[60:63], v[108:111], a[4:7], 0
    ds_read_b64_tr_b16 v[142:143], v20 offset:17408
    s_waitcnt vmcnt(13) lgkmcnt(14)
    v_mfma_f32_16x16x32_bf16 v[32:35], v[112:115], a[8:11], v[32:35]
    ds_read_b64_tr_b16 v[96:97], v64 offset:0
    s_waitcnt vmcnt(1)
    v_subrev_u32 v6, s73, v6
    v_cmp_le_u32 vcc, 1, v6
    s_nop 0
    s_cmp_eq_u64 vcc, 0
    s_cbranch_scc1 L_pd11
    s_mov_b32 s96, 300000
L_pl11:
    s_sleep 10
    buffer_load_dword v6, v25, s[16:19], s68 offen sc1
    s_waitcnt vmcnt(0)
    v_subrev_u32 v6, s73, v6
    v_cmp_le_u32 vcc, 1, v6
    s_sub_u32 s96, s96, 1
    s_cmp_eq_u32 s96, 0
    s_cbranch_scc1 L_pd11
    s_cmp_eq_u64 vcc, 0
    s_cbranch_scc0 L_pl11
L_pd11:
    s_waitcnt lgkmcnt(13)
    v_mfma_f32_16x16x32_bf16 v[36:39], v[116:119], a[8:11], v[36:39]
    ds_read_b64_tr_b16 v[98:99], v64 offset:1024
    buffer_load_dwordx4 a[56:59], v13, s[16:19], s4 offen offset:2048 sc1
    s_waitcnt lgkmcnt(12)
    v_mfma_f32_16x16x32_bf16 v[40:43], v[120:123], a[8:11], v[40:43]
    ds_read_b64_tr_b16 v[100:101], v65 offset:0
    buffer_load_dwordx4 a[60:63], v15, s[16:19], s4 offen offset:2048 sc1
    s_waitcnt lgkmcnt(11)
    v_mfma_f32_16x16x32_bf16 v[44:47], v[124:127], a[8:11], v[44:47]
    ds_read_b64_tr_b16 v[102:103], v65 offset:1024
    buffer_load_dwordx4 a[64:67], v13, s[16:19], s5 offen offset:2048 sc1
    v_mfma_f32_16x16x32_bf16 v[48:51], v[112:115], a[12:15], v[48:51]
    ds_read_b64_tr_b16 v[104:105], v66 offset:0
    buffer_load_dwordx4 a[68:71], v15, s[16:19], s5 offen offset:2048 sc1
    v_mfma_f32_16x16x32_bf16 v[52:55], v[116:119], a[12:15], v[52:55]
    ds_read_b64_tr_b16 v[106:107], v66 offset:1024
    buffer_load_dwordx4 a[72:75], v13, s[16:19], s6 offen offset:2048 sc1
    v_mfma_f32_16x16x32_bf16 v[56:59], v[120:123], a[12:15], v[56:59]
    ds_read_b64_tr_b16 v[108:109], v67 offset:0
    buffer_load_dwordx4 a[76:79], v15, s[16:19], s6 offen offset:2048 sc1
    v_mfma_f32_16x16x32_bf16 v[60:63], v[124:127], a[12:15], v[60:63]
    ds_read_b64_tr_b16 v[110:111], v67 offset:1024
    s_waitcnt lgkmcnt(14)
    v_mfma_f32_16x16x32_bf16 v[32:35], v[128:131], a[16:19], v[32:35]
    ds_read_b64_tr_b16 v[112:113], v64 offset:8192
    buffer_load_dwordx4 a[80:83], v13, s[16:19], s7 offen offset:2048 sc1
    s_waitcnt lgkmcnt(13)
    v_mfma_f32_16x16x32_bf16 v[36:39], v[132:135], a[16:19], v[36:39]
    ds_read_b64_tr_b16 v[114:115], v64 offset:9216
    buffer_load_dwordx4 a[84:87], v15, s[16:19], s7 offen offset:2048 sc1
    s_waitcnt lgkmcnt(12)
    v_mfma_f32_16x16x32_bf16 v[40:43], v[136:139], a[16:19], v[40:43]
    ds_read_b64_tr_b16 v[116:117], v65 offset:8192
    buffer_load_dwordx4 a[88:91], v13, s[16:19], s40 offen offset:2048 sc1
    s_waitcnt lgkmcnt(11)
    v_mfma_f32_16x16x32_bf16 v[44:47], v[140:143], a[16:19], v[44:47]
    ds_read_b64_tr_b16 v[118:119], v65 offset:9216
    v_mfma_f32_16x16x32_bf16 v[48:51], v[128:131], a[20:23], v[48:51]
    ds_read_b64_tr_b16 v[120:121], v66 offset:8192
    buffer_load_dwordx4 a[92:95], v15, s[16:19], s40 offen offset:2048 sc1
    v_mfma_f32_16x16x32_bf16 v[52:55], v[132:135], a[20:23], v[52:55]
    ds_read_b64_tr_b16 v[122:123], v66 offset:9216
    buffer_load_dwordx4 a[96:99], v13, s[16:19], s41 offen offset:2048 sc1
    v_mfma_f32_16x16x32_bf16 v[56:59], v[136:139], a[20:23], v[56:59]
    ds_read_b64_tr_b16 v[124:125], v67 offset:8192
    v_mov_b32 v28, 4
    ds_write_b32 v26, v28 offset:32
    v_mfma_f32_16x16x32_bf16 v[60:63], v[140:143], a[20:23], v[60:63]
    ds_read_b64_tr_b16 v[126:127], v67 offset:9216
    s_waitcnt lgkmcnt(15)
    v_mfma_f32_16x16x32_bf16 v[32:35], v[96:99], a[24:27], v[32:35]
    ds_read_b64_tr_b16 v[128:129], v64 offset:16384
    s_waitcnt lgkmcnt(14)
    v_mfma_f32_16x16x32_bf16 v[36:39], v[100:103], a[24:27], v[36:39]
    ds_read_b64_tr_b16 v[130:131], v64 offset:17408
    s_waitcnt lgkmcnt(13)
    v_mfma_f32_16x16x32_bf16 v[40:43], v[104:107], a[24:27], v[40:43]
    ds_read_b64_tr_b16 v[132:133], v65 offset:16384
    s_waitcnt lgkmcnt(12)
    v_mfma_f32_16x16x32_bf16 v[44:47], v[108:111], a[24:27], v[44:47]
    ds_read_b64_tr_b16 v[134:135], v65 offset:17408
    v_mfma_f32_16x16x32_bf16 v[48:51], v[96:99], a[28:31], v[48:51]
    ds_read_b64_tr_b16 v[136:137], v66 offset:16384
    v_mfma_f32_16x16x32_bf16 v[52:55], v[100:103], a[28:31], v[52:55]
    ds_read_b64_tr_b16 v[138:139], v66 offset:17408
    v_mfma_f32_16x16x32_bf16 v[56:59], v[104:107], a[28:31], v[56:59]
    ds_read_b64_tr_b16 v[140:141], v67 offset:16384
    v_mfma_f32_16x16x32_bf16 v[60:63], v[108:111], a[28:31], v[60:63]
    ds_read_b64_tr_b16 v[142:143], v67 offset:17408
    s_waitcnt lgkmcnt(15)
    v_mfma_f32_16x16x32_bf16 v[32:35], v[112:115], a[32:35], v[32:35]
    ds_read_b64_tr_b16 v[96:97], v64 offset:24576
    s_waitcnt lgkmcnt(14)
    v_mfma_f32_16x16x32_bf16 v[36:39], v[116:119], a[32:35], v[36:39]
    ds_read_b64_tr_b16 v[98:99], v64 offset:25600
    s_waitcnt lgkmcnt(13)
    v_mfma_f32_16x16x32_bf16 v[40:43], v[120:123], a[32:35], v[40:43]
    ds_read_b64_tr_b16 v[100:101], v65 offset:24576
    s_waitcnt lgkmcnt(11)
    v_mfma_f32_16x16x32_bf16 v[44:47], v[124:127], a[32:35], v[44:47]
    ds_read_b64_tr_b16 v[102:103], v65 offset:25600
    v_mfma_f32_16x16x32_bf16 v[48:51], v[112:115], a[36:39], v[48:51]
    ds_read_b64_tr_b16 v[104:105], v66 offset:24576
    v_mfma_f32_16x16x32_bf16 v[52:55], v[116:119], a[36:39], v[52:55]
    ds_read_b64_tr_b16 v[106:107], v66 offset:25600
    v_mfma_f32_16x16x32_bf16 v[56:59], v[120:123], a[36:39], v[56:59]
    ds_read_b64_tr_b16 v[108:109], v67 offset:24576
    v_mfma_f32_16x16x32_bf16 v[60:63], v[124:127], a[36:39], v[60:63]
    ds_read_b64_tr_b16 v[110:111], v67 offset:25600
    s_waitcnt lgkmcnt(14)
    v_mfma_f32_16x16x32_bf16 v[32:35], v[128:131], a[40:43], v[32:35]
    ds_read_b64_tr_b16 v[112:113], v17 offset:4096
    s_waitcnt lgkmcnt(13)
    v_mfma_f32_16x16x32_bf16 v[36:39], v[132:135], a[40:43], v[36:39]
    ds_read_b64_tr_b16 v[114:115], v17 offset:5120
    s_waitcnt lgkmcnt(12)
    v_mfma_f32_16x16x32_bf16 v[40:43], v[136:139], a[40:43], v[40:43]
    ds_read_b64_tr_b16 v[116:117], v18 offset:4096
    s_waitcnt lgkmcnt(11)
    v_mfma_f32_16x16x32_bf16 v[44:47], v[140:143], a[40:43], v[44:47]
    ds_read_b64_tr_b16 v[118:119], v18 offset:5120
    v_mfma_f32_16x16x32_bf16 v[48:51], v[128:131], a[44:47], v[48:51]
    ds_read_b64_tr_b16 v[120:121], v19 offset:4096
    v_mfma_f32_16x16x32_bf16 v[52:55], v[132:135], a[44:47], v[52:55]
    ds_read_b64_tr_b16 v[122:123], v19 offset:5120
    v_mfma_f32_16x16x32_bf16 v[56:59], v[136:139], a[44:47], v[56:59]
    ds_read_b64_tr_b16 v[124:125], v20 offset:4096
    v_mfma_f32_16x16x32_bf16 v[60:63], v[140:143], a[44:47], v[60:63]
    ds_read_b64_tr_b16 v[126:127], v20 offset:5120
    s_waitcnt lgkmcnt(14)
    v_mfma_f32_16x16x32_bf16 v[32:35], v[96:99], a[48:51], v[32:35]
    ds_read_b64_tr_b16 v[128:129], v17 offset:12288
    s_waitcnt lgkmcnt(13)
    v_mfma_f32_16x16x32_bf16 v[36:39], v[100:103], a[48:51], v[36:39]
    ds_read_b64_tr_b16 v[130:131], v17 offset:13312
    s_waitcnt lgkmcnt(12)
    v_mfma_f32_16x16x32_bf16 v[40:43], v[104:107], a[48:51], v[40:43]
    ds_read_b64_tr_b16 v[132:133], v18 offset:12288
    s_waitcnt lgkmcnt(11)
    v_mfma_f32_16x16x32_bf16 v[44:47], v[108:111], a[48:51], v[44:47]
    ds_read_b64_tr_b16 v[134:135], v18 offset:13312
    v_mfma_f32_16x16x32_bf16 v[48:51], v[96:99], a[52:55], v[48:51]
    ds_read_b64_tr_b16 v[136:137], v19 offset:12288
    v_mfma_f32_16x16x32_bf16 v[52:55], v[100:103], a[52:55], v[52:55]
    ds_read_b64_tr_b16 v[138:139], v19 offset:13312
    v_mfma_f32_16x16x32_bf16 v[56:59], v[104:107], a[52:55], v[56:59]
    ds_read_b64_tr_b16 v[140:141], v20 offset:12288
    v_mfma_f32_16x16x32_bf16 v[60:63], v[108:111], a[52:55], v[60:63]
    ds_read_b64_tr_b16 v[142:143], v20 offset:13312
    s_waitcnt vmcnt(10) lgkmcnt(14)
    v_mfma_f32_16x16x32_bf16 v[32:35], v[112:115], a[56:59], v[32:35]
    ds_read_b64_tr_b16 v[96:97], v17 offset:20480
    s_waitcnt lgkmcnt(13)
    v_mfma_f32_16x16x32_bf16 v[36:39], v[116:119], a[56:59], v[36:39]
    ds_read_b64_tr_b16 v[98:99], v17 offset:21504
    s_waitcnt lgkmcnt(12)
    v_mfma_f32_16x16x32_bf16 v[40:43], v[120:123], a[56:59], v[40:43]
    ds_read_b64_tr_b16 v[100:101], v18 offset:20480
    s_waitcnt lgkmcnt(11)
    v_mfma_f32_16x16x32_bf16 v[44:47], v[124:127], a[56:59], v[44:47]
    ds_read_b64_tr_b16 v[102:103], v18 offset:21504
    s_waitcnt vmcnt(9)
    v_mfma_f32_16x16x32_bf16 v[48:51], v[112:115], a[60:63], v[48:51]
    ds_read_b64_tr_b16 v[104:105], v19 offset:20480
    v_mfma_f32_16x16x32_bf16 v[52:55], v[116:119], a[60:63], v[52:55]
    ds_read_b64_tr_b16 v[106:107], v19 offset:21504
    v_mfma_f32_16x16x32_bf16 v[56:59], v[120:123], a[60:63], v[56:59]
    ds_read_b64_tr_b16 v[108:109], v20 offset:20480
    v_mfma_f32_16x16x32_bf16 v[60:63], v[124:127], a[60:63], v[60:63]
    ds_read_b64_tr_b16 v[110:111], v20 offset:21504
    s_waitcnt vmcnt(8) lgkmcnt(14)
    v_mfma_f32_16x16x32_bf16 v[32:35], v[128:131], a[64:67], v[32:35]
    ds_read_b64_tr_b16 v[112:113], v64 offset:4096
    buffer_load_dword v6, v25, s[16:19], s69 offen sc1
    s_waitcnt lgkmcnt(13)
    v_mfma_f32_16x16x32_bf16 v[36:39], v[132:135], a[64:67], v[36:39]
    ds_read_b64_tr_b16 v[114:115], v64 offset:5120
    s_waitcnt lgkmcnt(12)
    v_mfma_f32_16x16x32_bf16 v[40:43], v[136:139], a[64:67], v[40:43]
    ds_read_b64_tr_b16 v[116:117], v65 offset:4096
    s_waitcnt lgkmcnt(11)
    v_mfma_f32_16x16x32_bf16 v[44:47], v[140:143], a[64:67], v[44:47]
    ds_read_b64_tr_b16 v[118:119], v65 offset:5120
    s_waitcnt vmcnt(8)
    v_mfma_f32_16x16x32_bf16 v[48:51], v[128:131], a[68:71], v[48:51]
    ds_read_b64_tr_b16 v[120:121], v66 offset:4096
    buffer_load_dwordx4 a[100:103], v15, s[16:19], s41 offen offset:2048 sc1
    v_mfma_f32_16x16x32_bf16 v[52:55], v[132:135], a[68:71], v[52:55]
    ds_read_b64_tr_b16 v[122:123], v66 offset:5120
    v_mfma_f32_16x16x32_bf16 v[56:59], v[136:139], a[68:71], v[56:59]
    ds_read_b64_tr_b16 v[124:125], v67 offset:4096
    v_mfma_f32_16x16x32_bf16 v[60:63], v[140:143], a[68:71], v[60:63]
    ds_read_b64_tr_b16 v[126:127], v67 offset:5120
    s_waitcnt vmcnt(8) lgkmcnt(14)
    v_mfma_f32_16x16x32_bf16 v[32:35], v[96:99], a[72:75], v[32:35]
    ds_read_b64_tr_b16 v[128:129], v64 offset:12288
    buffer_load_dwordx4 a[104:107], v13, s[16:19], s42 offen offset:2048 sc1
    s_waitcnt lgkmcnt(13)
    v_mfma_f32_16x16x32_bf16 v[36:39], v[100:103], a[72:75], v[36:39]
    ds_read_b64_tr_b16 v[130:131], v64 offset:13312
    s_waitcnt lgkmcnt(12)
    v_mfma_f32_16x16x32_bf16 v[40:43], v[104:107], a[72:75], v[40:43]
    ds_read_b64_tr_b16 v[132:133], v65 offset:12288
    s_waitcnt lgkmcnt(11)
    v_mfma_f32_16x16x32_bf16 v[44:47], v[108:111], a[72:75], v[44:47]
    ds_read_b64_tr_b16 v[134:135], v65 offset:13312
    s_waitcnt vmcnt(8)
    v_mfma_f32_16x16x32_bf16 v[48:51], v[96:99], a[76:79], v[48:51]
    ds_read_b64_tr_b16 v[136:137], v66 offset:12288
    buffer_load_dwordx4 a[108:111], v15, s[16:19], s42 offen offset:2048 sc1
    v_mfma_f32_16x16x32_bf16 v[52:55], v[100:103], a[76:79], v[52:55]
    ds_read_b64_tr_b16 v[138:139], v66 offset:13312
    v_mfma_f32_16x16x32_bf16 v[56:59], v[104:107], a[76:79], v[56:59]
    ds_read_b64_tr_b16 v[140:141], v67 offset:12288
    v_mfma_f32_16x16x32_bf16 v[60:63], v[108:111], a[76:79], v[60:63]
    ds_read_b64_tr_b16 v[142:143], v67 offset:13312
    s_waitcnt vmcnt(8) lgkmcnt(14)
    v_mfma_f32_16x16x32_bf16 v[32:35], v[112:115], a[80:83], v[32:35]
    ds_read_b64_tr_b16 v[96:97], v64 offset:20480
    s_waitcnt vmcnt(3)
    v_subrev_u32 v6, s73, v6
    v_cmp_le_u32 vcc, 1, v6
    s_nop 0
    s_cmp_eq_u64 vcc, 0
    s_cbranch_scc1 L_pd12
    s_mov_b32 s96, 300000
L_pl12:
    s_sleep 10
    buffer_load_dword v6, v25, s[16:19], s69 offen sc1
    s_waitcnt vmcnt(0)
    v_subrev_u32 v6, s73, v6
    v_cmp_le_u32 vcc, 1, v6
    s_sub_u32 s96, s96, 1
    s_cmp_eq_u32 s96, 0
    s_cbranch_scc1 L_pd12
    s_cmp_eq_u64 vcc, 0
    s_cbranch_scc0 L_pl12
L_pd12:
    s_waitcnt lgkmcnt(13)
    v_mfma_f32_16x16x32_bf16 v[36:39], v[116:119], a[80:83], v[36:39]
    ds_read_b64_tr_b16 v[98:99], v64 offset:21504
    s_waitcnt lgkmcnt(12)
    v_mfma_f32_16x16x32_bf16 v[40:43], v[120:123], a[80:83], v[40:43]
    ds_read_b64_tr_b16 v[100:101], v65 offset:20480
    buffer_load_dwordx4 a[0:3], v14, s[16:19], s4 offen offset:0 sc1
    s_waitcnt lgkmcnt(11)
    v_mfma_f32_16x16x32_bf16 v[44:47], v[124:127], a[80:83], v[44:47]
    ds_read_b64_tr_b16 v[102:103], v65 offset:21504
    v_mfma_f32_16x16x32_bf16 v[48:51], v[112:115], a[84:87], v[48:51]
    ds_read_b64_tr_b16 v[104:105], v66 offset:20480
    v_mfma_f32_16x16x32_bf16 v[52:55], v[116:119], a[84:87], v[52:55]
    ds_read_b64_tr_b16 v[106:107], v66 offset:21504
    buffer_load_dwordx4 a[4:7], v14, s[16:19], s5 offen offset:0 sc1
    v_mfma_f32_16x16x32_bf16 v[56:59], v[120:123], a[84:87], v[56:59]
    ds_read_b64_tr_b16 v[108:109], v67 offset:20480
    v_mfma_f32_16x16x32_bf16 v[60:63], v[124:127], a[84:87], v[60:63]
    ds_read_b64_tr_b16 v[110:111], v67 offset:21504
    s_waitcnt lgkmcnt(14)
    v_mfma_f32_16x16x32_bf16 v[32:35], v[128:131], a[88:91], v[32:35]
    ds_read_b64_tr_b16 v[112:113], v64 offset:28672
    buffer_load_dwordx4 a[8:11], v14, s[16:19], s6 offen offset:0 sc1
    s_waitcnt lgkmcnt(13)
    v_mfma_f32_16x16x32_bf16 v[36:39], v[132:135], a[88:91], v[36:39]
    ds_read_b64_tr_b16 v[114:115], v64 offset:29696
    s_waitcnt lgkmcnt(12)
    v_mfma_f32_16x16x32_bf16 v[40:43], v[136:139], a[88:91], v[40:43]
    ds_read_b64_tr_b16 v[116:117], v65 offset:28672
    s_waitcnt lgkmcnt(11)
    v_mfma_f32_16x16x32_bf16 v[44:47], v[140:143], a[88:91], v[44:47]
    ds_read_b64_tr_b16 v[118:119], v65 offset:29696
    v_mfma_f32_16x16x32_bf16 v[48:51], v[128:131], a[92:95], v[48:51]
    ds_read_b64_tr_b16 v[120:121], v66 offset:28672
    buffer_load_dwordx4 a[12:15], v14, s[16:19], s7 offen offset:0 sc1
    v_mfma_f32_16x16x32_bf16 v[52:55], v[132:135], a[92:95], v[52:55]
    ds_read_b64_tr_b16 v[122:123], v66 offset:29696
    v_mfma_f32_16x16x32_bf16 v[56:59], v[136:139], a[92:95], v[56:59]
    ds_read_b64_tr_b16 v[124:125], v67 offset:28672
    v_mfma_f32_16x16x32_bf16 v[60:63], v[140:143], a[92:95], v[60:63]
    ds_read_b64_tr_b16 v[126:127], v67 offset:29696
    s_waitcnt lgkmcnt(14)
    v_mfma_f32_16x16x32_bf16 v[32:35], v[96:99], a[96:99], v[32:35]
    ds_read_b64_tr_b16 v[128:129], v64 offset:32768
    buffer_load_dwordx4 a[16:19], v14, s[16:19], s40 offen offset:0 sc1
    s_waitcnt lgkmcnt(13)
    v_mfma_f32_16x16x32_bf16 v[36:39], v[100:103], a[96:99], v[36:39]
    ds_read_b64_tr_b16 v[130:131], v64 offset:33792
    s_waitcnt lgkmcnt(12)
    v_mfma_f32_16x16x32_bf16 v[40:43], v[104:107], a[96:99], v[40:43]
    ds_read_b64_tr_b16 v[132:133], v65 offset:32768
    s_waitcnt lgkmcnt(11)
    v_mfma_f32_16x16x32_bf16 v[44:47], v[108:111], a[96:99], v[44:47]
    ds_read_b64_tr_b16 v[134:135], v65 offset:33792
    s_waitcnt vmcnt(7)
    v_mfma_f32_16x16x32_bf16 v[48:51], v[96:99], a[100:103], v[48:51]
    ds_read_b64_tr_b16 v[136:137], v66 offset:32768
    buffer_load_dwordx4 a[20:23], v14, s[16:19], s41 offen offset:0 sc1
    v_mfma_f32_16x16x32_bf16 v[52:55], v[100:103], a[100:103], v[52:55]
    ds_read_b64_tr_b16 v[138:139], v66 offset:33792
    v_mfma_f32_16x16x32_bf16 v[56:59], v[104:107], a[100:103], v[56:59]
    ds_read_b64_tr_b16 v[140:141], v67 offset:32768
    v_mfma_f32_16x16x32_bf16 v[60:63], v[108:111], a[100:103], v[60:63]
    ds_read_b64_tr_b16 v[142:143], v67 offset:33792
    s_waitcnt vmcnt(7) lgkmcnt(14)
    v_mfma_f32_16x16x32_bf16 v[32:35], v[112:115], a[104:107], v[32:35]
    ds_read_b64_tr_b16 v[96:97], v64 offset:40960
    buffer_load_dwordx4 a[24:27], v14, s[16:19], s42 offen offset:0 sc1
    s_waitcnt lgkmcnt(13)
    v_mfma_f32_16x16x32_bf16 v[36:39], v[116:119], a[104:107], v[36:39]
    ds_read_b64_tr_b16 v[98:99], v64 offset:41984
    s_waitcnt lgkmcnt(12)
    v_mfma_f32_16x16x32_bf16 v[40:43], v[120:123], a[104:107], v[40:43]
    ds_read_b64_tr_b16 v[100:101], v65 offset:40960
    s_waitcnt lgkmcnt(11)
    v_mfma_f32_16x16x32_bf16 v[44:47], v[124:127], a[104:107], v[44:47]
    ds_read_b64_tr_b16 v[102:103], v65 offset:41984
    s_waitcnt vmcnt(7)
    v_mfma_f32_16x16x32_bf16 v[48:51], v[112:115], a[108:111], v[48:51]
    ds_read_b64_tr_b16 v[104:105], v66 offset:40960
    buffer_load_dwordx4 a[28:31], v14, s[16:19], s4 offen offset:2048 sc1
    v_mfma_f32_16x16x32_bf16 v[52:55], v[116:119], a[108:111], v[52:55]
    ds_read_b64_tr_b16 v[106:107], v66 offset:41984
    v_mfma_f32_16x16x32_bf16 v[56:59], v[120:123], a[108:111], v[56:59]
    ds_read_b64_tr_b16 v[108:109], v67 offset:40960
    v_mfma_f32_16x16x32_bf16 v[60:63], v[124:127], a[108:111], v[60:63]
    ds_read_b64_tr_b16 v[110:111], v67 offset:41984
    s_waitcnt vmcnt(7) lgkmcnt(14)
    v_mfma_f32_16x16x32_bf16 v[32:35], v[128:131], a[0:3], v[32:35]
    ds_read_b64_tr_b16 v[112:113], v64 offset:49152
    ds_read_b64_tr_b16 v[114:115], v64 offset:50176
    buffer_load_dwordx4 a[32:35], v14, s[16:19], s5 offen offset:2048 sc1
    s_waitcnt lgkmcnt(14)
    v_mfma_f32_16x16x32_bf16 v[36:39], v[132:135], a[0:3], v[36:39]
    ds_read_b64_tr_b16 v[116:117], v65 offset:49152
    ds_read_b64_tr_b16 v[118:119], v65 offset:50176
    s_waitcnt lgkmcnt(14)
    v_mfma_f32_16x16x32_bf16 v[40:43], v[136:139], a[0:3], v[40:43]
    ds_read_b64_tr_b16 v[120:121], v66 offset:49152
    ds_read_b64_tr_b16 v[122:123], v66 offset:50176
    s_waitcnt lgkmcnt(14)
    v_mfma_f32_16x16x32_bf16 v[44:47], v[140:143], a[0:3], v[44:47]
    ds_read_b64_tr_b16 v[124:125], v67 offset:49152
    ds_read_b64_tr_b16 v[126:127], v67 offset:50176
    s_waitcnt vmcnt(7) lgkmcnt(14)
    v_mfma_f32_16x16x32_bf16 v[32:35], v[96:99], a[4:7], v[32:35]
    ds_read_b64_tr_b16 v[128:129], v68 offset:0
    ds_read_b64_tr_b16 v[130:131], v68 offset:1024
    buffer_load_dwordx4 a[36:39], v14, s[16:19], s6 offen offset:2048 sc1
    s_waitcnt lgkmcnt(14)
    v_mfma_f32_16x16x32_bf16 v[36:39], v[100:103], a[4:7], v[36:39]
    ds_read_b64_tr_b16 v[132:133], v69 offset:0
    ds_read_b64_tr_b16 v[134:135], v69 offset:1024
    s_waitcnt lgkmcnt(14)
    v_mfma_f32_16x16x32_bf16 v[40:43], v[104:107], a[4:7], v[40:43]
    ds_read_b64_tr_b16 v[136:137], v70 offset:0
    ds_read_b64_tr_b16 v[138:139], v70 offset:1024
    s_waitcnt lgkmcnt(14)
    v_mfma_f32_16x16x32_bf16 v[44:47], v[108:111], a[4:7], v[44:47]
    ds_read_b64_tr_b16 v[140:141], v71 offset:0
    ds_read_b64_tr_b16 v[142:143], v71 offset:1024
    s_waitcnt vmcnt(7) lgkmcnt(14)
    v_mfma_f32_16x16x32_bf16 v[32:35], v[112:115], a[8:11], v[32:35]
    ds_read_b64_tr_b16 v[96:97], v68 offset:8192
    ds_read_b64_tr_b16 v[98:99], v68 offset:9216
    buffer_load_dwordx4 a[40:43], v14, s[16:19], s7 offen offset:2048 sc1
    s_waitcnt lgkmcnt(14)
    v_mfma_f32_16x16x32_bf16 v[36:39], v[116:119], a[8:11], v[36:39]
    ds_read_b64_tr_b16 v[100:101], v69 offset:8192
    ds_read_b64_tr_b16 v[102:103], v69 offset:9216
    s_waitcnt lgkmcnt(14)
    v_mfma_f32_16x16x32_bf16 v[40:43], v[120:123], a[8:11], v[40:43]
    ds_read_b64_tr_b16 v[104:105], v70 offset:8192
    ds_read_b64_tr_b16 v[106:107], v70 offset:9216
    s_waitcnt lgkmcnt(14)
    v_mfma_f32_16x16x32_bf16 v[44:47], v[124:127], a[8:11], v[44:47]
    ds_read_b64_tr_b16 v[108:109], v71 offset:8192
    ds_read_b64_tr_b16 v[110:111], v71 offset:9216
    s_waitcnt vmcnt(7) lgkmcnt(14)
    v_mfma_f32_16x16x32_bf16 v[32:35], v[128:131], a[12:15], v[32:35]
    ds_read_b64_tr_b16 v[112:113], v68 offset:16384
    ds_read_b64_tr_b16 v[114:115], v68 offset:17408
    buffer_load_dwordx4 a[44:47], v14, s[16:19], s40 offen offset:2048 sc1
    s_waitcnt lgkmcnt(14)
    v_mfma_f32_16x16x32_bf16 v[36:39], v[132:135], a[12:15], v[36:39]
    ds_read_b64_tr_b16 v[116:117], v69 offset:16384
    ds_read_b64_tr_b16 v[118:119], v69 offset:17408
    s_waitcnt lgkmcnt(14)
    v_mfma_f32_16x16x32_bf16 v[40:43], v[136:139], a[12:15], v[40:43]
    ds_read_b64_tr_b16 v[120:121], v70 offset:16384
    ds_read_b64_tr_b16 v[122:123], v70 offset:17408
    s_waitcnt lgkmcnt(14)
    v_mfma_f32_16x16x32_bf16 v[44:47], v[140:143], a[12:15], v[44:47]
    ds_read_b64_tr_b16 v[124:125], v71 offset:16384
    ds_read_b64_tr_b16 v[126:127], v71 offset:17408
    s_waitcnt vmcnt(7) lgkmcnt(14)
    v_mfma_f32_16x16x32_bf16 v[32:35], v[96:99], a[16:19], v[32:35]
    ds_read_b64_tr_b16 v[128:129], v68 offset:24576
    ds_read_b64_tr_b16 v[130:131], v68 offset:25600
    buffer_load_dwordx4 a[48:51], v14, s[16:19], s41 offen offset:2048 sc1
    s_waitcnt lgkmcnt(14)
    v_mfma_f32_16x16x32_bf16 v[36:39], v[100:103], a[16:19], v[36:39]
    ds_read_b64_tr_b16 v[132:133], v69 offset:24576
    ds_read_b64_tr_b16 v[134:135], v69 offset:25600
    s_waitcnt lgkmcnt(14)
    v_mfma_f32_16x16x32_bf16 v[40:43], v[104:107], a[16:19], v[40:43]
    ds_read_b64_tr_b16 v[136:137], v70 offset:24576
    ds_read_b64_tr_b16 v[138:139], v70 offset:25600
    s_waitcnt lgkmcnt(14)
    v_mfma_f32_16x16x32_bf16 v[44:47], v[108:111], a[16:19], v[44:47]
    ds_read_b64_tr_b16 v[140:141], v71 offset:24576
    ds_read_b64_tr_b16 v[142:143], v71 offset:25600
    s_waitcnt vmcnt(7) lgkmcnt(14)
    v_mfma_f32_16x16x32_bf16 v[32:35], v[112:115], a[20:23], v[32:35]
    ds_read_b64_tr_b16 v[96:97], v64 offset:36864
    ds_read_b64_tr_b16 v[98:99], v64 offset:37888
    buffer_load_dwordx4 a[52:55], v14, s[16:19], s42 offen offset:2048 sc1
    s_waitcnt lgkmcnt(14)
    v_mfma_f32_16x16x32_bf16 v[36:39], v[116:119], a[20:23], v[36:39]
    ds_read_b64_tr_b16 v[100:101], v65 offset:36864
    ds_read_b64_tr_b16 v[102:103], v65 offset:37888
    s_waitcnt lgkmcnt(14)
    v_mfma_f32_16x16x32_bf16 v[40:43], v[120:123], a[20:23], v[40:43]
    ds_read_b64_tr_b16 v[104:105], v66 offset:36864
    ds_read_b64_tr_b16 v[106:107], v66 offset:37888
    s_waitcnt lgkmcnt(14)
    v_mfma_f32_16x16x32_bf16 v[44:47], v[124:127], a[20:23], v[44:47]
    ds_read_b64_tr_b16 v[108:109], v67 offset:36864
    ds_read_b64_tr_b16 v[110:111], v67 offset:37888
    s_waitcnt vmcnt(7) lgkmcnt(14)
    v_mfma_f32_16x16x32_bf16 v[32:35], v[128:131], a[24:27], v[32:35]
    ds_read_b64_tr_b16 v[112:113], v64 offset:45056
    ds_read_b64_tr_b16 v[114:115], v64 offset:46080
    buffer_load_dwordx4 a[56:59], v16, s[16:19], s4 offen offset:0 sc1
    s_waitcnt lgkmcnt(14)
    v_mfma_f32_16x16x32_bf16 v[36:39], v[132:135], a[24:27], v[36:39]
    ds_read_b64_tr_b16 v[116:117], v65 offset:45056
    ds_read_b64_tr_b16 v[118:119], v65 offset:46080
    s_waitcnt lgkmcnt(14)
    v_mfma_f32_16x16x32_bf16 v[40:43], v[136:139], a[24:27], v[40:43]
    ds_read_b64_tr_b16 v[120:121], v66 offset:45056
    ds_read_b64_tr_b16 v[122:123], v66 offset:46080
    s_waitcnt lgkmcnt(14)
    v_mfma_f32_16x16x32_bf16 v[44:47], v[140:143], a[24:27], v[44:47]
    ds_read_b64_tr_b16 v[124:125], v67 offset:45056
    ds_read_b64_tr_b16 v[126:127], v67 offset:46080
    s_waitcnt vmcnt(7) lgkmcnt(14)
    v_mfma_f32_16x16x32_bf16 v[32:35], v[96:99], a[28:31], v[32:35]
    ds_read_b64_tr_b16 v[128:129], v64 offset:53248
    ds_read_b64_tr_b16 v[130:131], v64 offset:54272
    buffer_load_dwordx4 a[60:63], v16, s[16:19], s5 offen offset:0 sc1
    s_waitcnt lgkmcnt(14)
    v_mfma_f32_16x16x32_bf16 v[36:39], v[100:103], a[28:31], v[36:39]
    ds_read_b64_tr_b16 v[132:133], v65 offset:53248
    ds_read_b64_tr_b16 v[134:135], v65 offset:54272
    s_waitcnt lgkmcnt(14)
    v_mfma_f32_16x16x32_bf16 v[40:43], v[104:107], a[28:31], v[40:43]
    ds_read_b64_tr_b16 v[136:137], v66 offset:53248
    ds_read_b64_tr_b16 v[138:139], v66 offset:54272
    s_waitcnt lgkmcnt(14)
    v_mfma_f32_16x16x32_bf16 v[44:47], v[108:111], a[28:31], v[44:47]
    ds_read_b64_tr_b16 v[140:141], v67 offset:53248
    ds_read_b64_tr_b16 v[142:143], v67 offset:54272
    s_waitcnt vmcnt(7) lgkmcnt(14)
    v_mfma_f32_16x16x32_bf16 v[32:35], v[112:115], a[32:35], v[32:35]
    ds_read_b64_tr_b16 v[96:97], v68 offset:4096
    ds_read_b64_tr_b16 v[98:99], v68 offset:5120
    buffer_load_dwordx4 a[64:67], v16, s[16:19], s6 offen offset:0 sc1
    s_waitcnt lgkmcnt(14)
    v_mfma_f32_16x16x32_bf16 v[36:39], v[116:119], a[32:35], v[36:39]
    ds_read_b64_tr_b16 v[100:101], v69 offset:4096
    ds_read_b64_tr_b16 v[102:103], v69 offset:5120
    s_waitcnt lgkmcnt(14)
    v_mfma_f32_16x16x32_bf16 v[40:43], v[120:123], a[32:35], v[40:43]
    ds_read_b64_tr_b16 v[104:105], v70 offset:4096
    ds_read_b64_tr_b16 v[106:107], v70 offset:5120
    s_waitcnt lgkmcnt(14)
    v_mfma_f32_16x16x32_bf16 v[44:47], v[124:127], a[32:35], v[44:47]
    ds_read_b64_tr_b16 v[108:109], v71 offset:4096
    ds_read_b64_tr_b16 v[110:111], v71 offset:5120
    s_waitcnt vmcnt(7) lgkmcnt(14)
    v_mfma_f32_16x16x32_bf16 v[32:35], v[128:131], a[36:39], v[32:35]
    ds_read_b64_tr_b16 v[112:113], v68 offset:12288
    ds_read_b64_tr_b16 v[114:115], v68 offset:13312
    buffer_load_dwordx4 a[68:71], v16, s[16:19], s7 offen offset:0 sc1
    s_waitcnt lgkmcnt(14)
    v_mfma_f32_16x16x32_bf16 v[36:39], v[132:135], a[36:39], v[36:39]
    ds_read_b64_tr_b16 v[116:117], v69 offset:12288
    ds_read_b64_tr_b16 v[118:119], v69 offset:13312
    s_waitcnt lgkmcnt(14)
    v_mfma_f32_16x16x32_bf16 v[40:43], v[136:139], a[36:39], v[40:43]
    ds_read_b64_tr_b16 v[120:121], v70 offset:12288
    ds_read_b64_tr_b16 v[122:123], v70 offset:13312
    s_waitcnt lgkmcnt(14)
    v_mfma_f32_16x16x32_bf16 v[44:47], v[140:143], a[36:39], v[44:47]
    ds_read_b64_tr_b16 v[124:125], v71 offset:12288
    ds_read_b64_tr_b16 v[126:127], v71 offset:13312
    s_waitcnt vmcnt(7) lgkmcnt(14)
    v_mfma_f32_16x16x32_bf16 v[32:35], v[96:99], a[40:43], v[32:35]
    ds_read_b64_tr_b16 v[128:129], v68 offset:20480
    ds_read_b64_tr_b16 v[130:131], v68 offset:21504
    buffer_load_dwordx4 a[72:75], v16, s[16:19], s40 offen offset:0 sc1
    s_waitcnt lgkmcnt(14)
    v_mfma_f32_16x16x32_bf16 v[36:39], v[100:103], a[40:43], v[36:39]
    ds_read_b64_tr_b16 v[132:133], v69 offset:20480
    ds_read_b64_tr_b16 v[134:135], v69 offset:21504
    s_waitcnt lgkmcnt(14)
    v_mfma_f32_16x16x32_bf16 v[40:43], v[104:107], a[40:43], v[40:43]
    ds_read_b64_tr_b16 v[136:137], v70 offset:20480
    ds_read_b64_tr_b16 v[138:139], v70 offset:21504
    s_waitcnt lgkmcnt(14)
    v_mfma_f32_16x16x32_bf16 v[44:47], v[108:111], a[40:43], v[44:47]
    ds_read_b64_tr_b16 v[140:141], v71 offset:20480
    ds_read_b64_tr_b16 v[142:143], v71 offset:21504
    s_waitcnt vmcnt(7) lgkmcnt(14)
    v_mfma_f32_16x16x32_bf16 v[32:35], v[112:115], a[44:47], v[32:35]
    ds_read_b64_tr_b16 v[96:97], v68 offset:28672
    ds_read_b64_tr_b16 v[98:99], v68 offset:29696
    buffer_load_dwordx4 a[76:79], v16, s[16:19], s41 offen offset:0 sc1
    s_waitcnt lgkmcnt(14)
    v_mfma_f32_16x16x32_bf16 v[36:39], v[116:119], a[44:47], v[36:39]
    ds_read_b64_tr_b16 v[100:101], v69 offset:28672
    ds_read_b64_tr_b16 v[102:103], v69 offset:29696
    s_waitcnt lgkmcnt(14)
    v_mfma_f32_16x16x32_bf16 v[40:43], v[120:123], a[44:47], v[40:43]
    ds_read_b64_tr_b16 v[104:105], v70 offset:28672
    ds_read_b64_tr_b16 v[106:107], v70 offset:29696
    s_waitcnt lgkmcnt(14)
    v_mfma_f32_16x16x32_bf16 v[44:47], v[124:127], a[44:47], v[44:47]
    ds_read_b64_tr_b16 v[108:109], v71 offset:28672
    ds_read_b64_tr_b16 v[110:111], v71 offset:29696
    s_waitcnt vmcnt(7) lgkmcnt(14)
    v_mfma_f32_16x16x32_bf16 v[32:35], v[128:131], a[48:51], v[32:35]
    ds_read_b64_tr_b16 v[112:113], v64 offset:32768
    ds_read_b64_tr_b16 v[114:115], v64 offset:33792
    buffer_load_dwordx4 a[80:83], v16, s[16:19], s42 offen offset:0 sc1
    s_waitcnt lgkmcnt(14)
    v_mfma_f32_16x16x32_bf16 v[36:39], v[132:135], a[48:51], v[36:39]
    ds_read_b64_tr_b16 v[116:117], v65 offset:32768
    ds_read_b64_tr_b16 v[118:119], v65 offset:33792
    s_waitcnt lgkmcnt(14)
    v_mfma_f32_16x16x32_bf16 v[40:43], v[136:139], a[48:51], v[40:43]
    ds_read_b64_tr_b16 v[120:121], v66 offset:32768
    ds_read_b64_tr_b16 v[122:123], v66 offset:33792
    s_waitcnt lgkmcnt(14)
    v_mfma_f32_16x16x32_bf16 v[44:47], v[140:143], a[48:51], v[44:47]
    ds_read_b64_tr_b16 v[124:125], v67 offset:32768
    ds_read_b64_tr_b16 v[126:127], v67 offset:33792
    s_waitcnt vmcnt(7) lgkmcnt(14)
    v_mfma_f32_16x16x32_bf16 v[32:35], v[96:99], a[52:55], v[32:35]
    ds_read_b64_tr_b16 v[128:129], v64 offset:40960
    ds_read_b64_tr_b16 v[130:131], v64 offset:41984
    buffer_load_dwordx4 a[84:87], v16, s[16:19], s4 offen offset:2048 sc1
    s_waitcnt lgkmcnt(14)
    v_mfma_f32_16x16x32_bf16 v[36:39], v[100:103], a[52:55], v[36:39]
    ds_read_b64_tr_b16 v[132:133], v65 offset:40960
    ds_read_b64_tr_b16 v[134:135], v65 offset:41984
    s_waitcnt lgkmcnt(14)
    v_mfma_f32_16x16x32_bf16 v[40:43], v[104:107], a[52:55], v[40:43]
    ds_read_b64_tr_b16 v[136:137], v66 offset:40960
    ds_read_b64_tr_b16 v[138:139], v66 offset:41984
    s_waitcnt lgkmcnt(14)
    v_mfma_f32_16x16x32_bf16 v[44:47], v[108:111], a[52:55], v[44:47]
    ds_read_b64_tr_b16 v[140:141], v67 offset:40960
    ds_read_b64_tr_b16 v[142:143], v67 offset:41984
    s_waitcnt vmcnt(7) lgkmcnt(14)
    v_mfma_f32_16x16x32_bf16 v[48:51], v[112:115], a[56:59], v[48:51]
    ds_read_b64_tr_b16 v[96:97], v64 offset:49152
    ds_read_b64_tr_b16 v[98:99], v64 offset:50176
    buffer_load_dwordx4 a[88:91], v16, s[16:19], s5 offen offset:2048 sc1
    v_mov_b32 v75, s73
    v_mov_b32 v79, s73
    v_mov_b32 v83, s73
    s_waitcnt lgkmcnt(14)
    v_mfma_f32_16x16x32_bf16 v[52:55], v[116:119], a[56:59], v[52:55]
    ds_read_b64_tr_b16 v[100:101], v65 offset:49152
    ds_read_b64_tr_b16 v[102:103], v65 offset:50176
    v_cvt_pk_bf16_f32 v72, v32, v33
    v_cvt_pk_bf16_f32 v73, v34, v35
    v_cvt_pk_bf16_f32 v74, v36, v37
    v_cvt_pk_bf16_f32 v76, v38, v39
    s_waitcnt lgkmcnt(14)
    v_mfma_f32_16x16x32_bf16 v[56:59], v[120:123], a[56:59], v[56:59]
    ds_read_b64_tr_b16 v[104:105], v66 offset:49152
    ds_read_b64_tr_b16 v[106:107], v66 offset:50176
    v_cvt_pk_bf16_f32 v77, v40, v41
    v_cvt_pk_bf16_f32 v78, v42, v43
    v_cvt_pk_bf16_f32 v80, v44, v45
    v_cvt_pk_bf16_f32 v81, v46, v47
    s_waitcnt lgkmcnt(14)
    v_mfma_f32_16x16x32_bf16 v[60:63], v[124:127], a[56:59], v[60:63]
    ds_read_b64_tr_b16 v[108:109], v67 offset:49152
    ds_read_b64_tr_b16 v[110:111], v67 offset:50176
    buffer_store_dwordx4 v[72:75], v7, s[16:19], s63 offen offset:0 sc1
    buffer_store_dwordx4 v[76:79], v7, s[16:19], s63 offen offset:1024 sc1
    buffer_store_dwordx4 v[80:83], v7, s[16:19], s63 offen offset:2048 sc1
    s_waitcnt vmcnt(10) lgkmcnt(14)
    v_mfma_f32_16x16x32_bf16 v[48:51], v[128:131], a[60:63], v[48:51]
    ds_read_b64_tr_b16 v[112:113], v68 offset:0
    ds_read_b64_tr_b16 v[114:115], v68 offset:1024
    buffer_load_dwordx4 a[92:95], v16, s[16:19], s6 offen offset:2048 sc1
    s_waitcnt lgkmcnt(14)
    v_mfma_f32_16x16x32_bf16 v[52:55], v[132:135], a[60:63], v[52:55]
    ds_read_b64_tr_b16 v[116:117], v69 offset:0
    ds_read_b64_tr_b16 v[118:119], v69 offset:1024
    s_waitcnt lgkmcnt(14)
    v_mfma_f32_16x16x32_bf16 v[56:59], v[136:139], a[60:63], v[56:59]
    ds_read_b64_tr_b16 v[120:121], v70 offset:0
    ds_read_b64_tr_b16 v[122:123], v70 offset:1024
    s_waitcnt lgkmcnt(14)
    v_mfma_f32_16x16x32_bf16 v[60:63], v[140:143], a[60:63], v[60:63]
    ds_read_b64_tr_b16 v[124:125], v71 offset:0
    ds_read_b64_tr_b16 v[126:127], v71 offset:1024
    s_waitcnt vmcnt(10) lgkmcnt(14)
    v_mfma_f32_16x16x32_bf16 v[48:51], v[96:99], a[64:67], v[48:51]
    ds_read_b64_tr_b16 v[128:129], v68 offset:8192
    ds_read_b64_tr_b16 v[130:131], v68 offset:9216
    buffer_load_dwordx4 a[96:99], v16, s[16:19], s7 offen offset:2048 sc1
    s_waitcnt lgkmcnt(14)
    v_mfma_f32_16x16x32_bf16 v[52:55], v[100:103], a[64:67], v[52:55]
    ds_read_b64_tr_b16 v[132:133], v69 offset:8192
    ds_read_b64_tr_b16 v[134:135], v69 offset:9216
    s_waitcnt lgkmcnt(14)
    v_mfma_f32_16x16x32_bf16 v[56:59], v[104:107], a[64:67], v[56:59]
    ds_read_b64_tr_b16 v[136:137], v70 offset:8192
    ds_read_b64_tr_b16 v[138:139], v70 offset:9216
    s_waitcnt lgkmcnt(14)
    v_mfma_f32_16x16x32_bf16 v[60:63], v[108:111], a[64:67], v[60:63]
    ds_read_b64_tr_b16 v[140:141], v71 offset:8192
    ds_read_b64_tr_b16 v[142:143], v71 offset:9216
    s_waitcnt vmcnt(10) lgkmcnt(14)
    v_mfma_f32_16x16x32_bf16 v[48:51], v[112:115], a[68:71], v[48:51]
    ds_read_b64_tr_b16 v[96:97], v68 offset:16384
    ds_read_b64_tr_b16 v[98:99], v68 offset:17408
    buffer_load_dwordx4 a[100:103], v16, s[16:19], s40 offen offset:2048 sc1
    s_waitcnt lgkmcnt(14)
    v_mfma_f32_16x16x32_bf16 v[52:55], v[116:119], a[68:71], v[52:55]
    ds_read_b64_tr_b16 v[100:101], v69 offset:16384
    ds_read_b64_tr_b16 v[102:103], v69 offset:17408
    s_waitcnt lgkmcnt(14)
    v_mfma_f32_16x16x32_bf16 v[56:59], v[120:123], a[68:71], v[56:59]
    ds_read_b64_tr_b16 v[104:105], v70 offset:16384
    ds_read_b64_tr_b16 v[106:107], v70 offset:17408
    s_waitcnt lgkmcnt(14)
    v_mfma_f32_16x16x32_bf16 v[60:63], v[124:127], a[68:71], v[60:63]
    ds_read_b64_tr_b16 v[108:109], v71 offset:16384
    ds_read_b64_tr_b16 v[110:111], v71 offset:17408
    s_waitcnt vmcnt(10) lgkmcnt(14)
    v_mfma_f32_16x16x32_bf16 v[48:51], v[128:131], a[72:75], v[48:51]
    ds_read_b64_tr_b16 v[112:113], v68 offset:24576
    ds_read_b64_tr_b16 v[114:115], v68 offset:25600
    buffer_load_dwordx4 a[104:107], v16, s[16:19], s41 offen offset:2048 sc1
    s_waitcnt lgkmcnt(14)
    v_mfma_f32_16x16x32_bf16 v[52:55], v[132:135], a[72:75], v[52:55]
    ds_read_b64_tr_b16 v[116:117], v69 offset:24576
    ds_read_b64_tr_b16 v[118:119], v69 offset:25600
    s_waitcnt lgkmcnt(14)
    v_mfma_f32_16x16x32_bf16 v[56:59], v[136:139], a[72:75], v[56:59]
    ds_read_b64_tr_b16 v[120:121], v70 offset:24576
    ds_read_b64_tr_b16 v[122:123], v70 offset:25600
    s_waitcnt lgkmcnt(14)
    v_mfma_f32_16x16x32_bf16 v[60:63], v[140:143], a[72:75], v[60:63]
    ds_read_b64_tr_b16 v[124:125], v71 offset:24576
    ds_read_b64_tr_b16 v[126:127], v71 offset:25600
    s_waitcnt vmcnt(10) lgkmcnt(14)
    v_mfma_f32_16x16x32_bf16 v[48:51], v[96:99], a[76:79], v[48:51]
    ds_read_b64_tr_b16 v[128:129], v64 offset:36864
    ds_read_b64_tr_b16 v[130:131], v64 offset:37888
    buffer_load_dwordx4 a[108:111], v16, s[16:19], s42 offen offset:2048 sc1
    s_waitcnt lgkmcnt(14)
    v_mfma_f32_16x16x32_bf16 v[52:55], v[100:103], a[76:79], v[52:55]
    ds_read_b64_tr_b16 v[132:133], v65 offset:36864
    ds_read_b64_tr_b16 v[134:135], v65 offset:37888
    s_waitcnt lgkmcnt(14)
    v_mfma_f32_16x16x32_bf16 v[56:59], v[104:107], a[76:79], v[56:59]
    ds_read_b64_tr_b16 v[136:137], v66 offset:36864
    ds_read_b64_tr_b16 v[138:139], v66 offset:37888
    s_waitcnt lgkmcnt(14)
    v_mfma_f32_16x16x32_bf16 v[60:63], v[108:111], a[76:79], v[60:63]
    ds_read_b64_tr_b16 v[140:141], v67 offset:36864
    ds_read_b64_tr_b16 v[142:143], v67 offset:37888
    s_waitcnt vmcnt(10) lgkmcnt(14)
    v_mfma_f32_16x16x32_bf16 v[48:51], v[112:115], a[80:83], v[48:51]
    ds_read_b64_tr_b16 v[96:97], v64 offset:45056
    ds_read_b64_tr_b16 v[98:99], v64 offset:46080
    s_waitcnt lgkmcnt(14)
    v_mfma_f32_16x16x32_bf16 v[52:55], v[116:119], a[80:83], v[52:55]
    ds_read_b64_tr_b16 v[100:101], v65 offset:45056
    ds_read_b64_tr_b16 v[102:103], v65 offset:46080
    s_waitcnt lgkmcnt(14)
    v_mfma_f32_16x16x32_bf16 v[56:59], v[120:123], a[80:83], v[56:59]
    ds_read_b64_tr_b16 v[104:105], v66 offset:45056
    ds_read_b64_tr_b16 v[106:107], v66 offset:46080
    s_waitcnt lgkmcnt(14)
    v_mfma_f32_16x16x32_bf16 v[60:63], v[124:127], a[80:83], v[60:63]
    ds_read_b64_tr_b16 v[108:109], v67 offset:45056
    ds_read_b64_tr_b16 v[110:111], v67 offset:46080
    s_waitcnt vmcnt(9) lgkmcnt(14)
    v_mfma_f32_16x16x32_bf16 v[48:51], v[128:131], a[84:87], v[48:51]
    ds_read_b64_tr_b16 v[112:113], v64 offset:53248
    ds_read_b64_tr_b16 v[114:115], v64 offset:54272
    s_waitcnt lgkmcnt(14)
    v_mfma_f32_16x16x32_bf16 v[52:55], v[132:135], a[84:87], v[52:55]
    ds_read_b64_tr_b16 v[116:117], v65 offset:53248
    ds_read_b64_tr_b16 v[118:119], v65 offset:54272
    s_waitcnt lgkmcnt(14)
    v_mfma_f32_16x16x32_bf16 v[56:59], v[136:139], a[84:87], v[56:59]
    ds_read_b64_tr_b16 v[120:121], v66 offset:53248
    ds_read_b64_tr_b16 v[122:123], v66 offset:54272
    s_waitcnt lgkmcnt(14)
    v_mfma_f32_16x16x32_bf16 v[60:63], v[140:143], a[84:87], v[60:63]
    ds_read_b64_tr_b16 v[124:125], v67 offset:53248
    ds_read_b64_tr_b16 v[126:127], v67 offset:54272
    s_waitcnt vmcnt(8) lgkmcnt(14)
    v_mfma_f32_16x16x32_bf16 v[48:51], v[96:99], a[88:91], v[48:51]
    ds_read_b64_tr_b16 v[128:129], v68 offset:4096
    ds_read_b64_tr_b16 v[130:131], v68 offset:5120
    s_mov_b32 s78, 114688
    v_and_b32 v14, 1, v4
    v_lshlrev_b32 v14, 5, v14
    v_lshrrev_b32 v15, 1, v4
    v_lshl_add_u32 v14, v15, 4, v14
    s_waitcnt lgkmcnt(14)
    v_mfma_f32_16x16x32_bf16 v[52:55], v[100:103], a[88:91], v[52:55]
    ds_read_b64_tr_b16 v[132:133], v69 offset:4096
    ds_read_b64_tr_b16 v[134:135], v69 offset:5120
    v_mad_u32_u24 v14, v8, s78, v14
    s_and_b32 s66, s72, 1
    s_lshl_b32 s66, s66, 6
    s_add_u32 s66, s66, s64
    s_waitcnt lgkmcnt(14)
    v_mfma_f32_16x16x32_bf16 v[56:59], v[104:107], a[88:91], v[56:59]
    ds_read_b64_tr_b16 v[136:137], v70 offset:4096
    ds_read_b64_tr_b16 v[138:139], v70 offset:5120
    s_mul_i32 s66, s66, 896
    s_lshl_b32 s78, s47, 7
    s_add_u32 s66, s66, s78
    s_mul_i32 s78, s72, 6144
    s_add_u32 s78, s78, 90112
    s_waitcnt lgkmcnt(14)
    v_mfma_f32_16x16x32_bf16 v[60:63], v[108:111], a[88:91], v[60:63]
    ds_read_b64_tr_b16 v[140:141], v71 offset:4096
    ds_read_b64_tr_b16 v[142:143], v71 offset:5120
    v_add_u32 v15, s78, v7
    s_lshl_b32 s78, s72, 6
    s_add_u32 s78, s78, 161792
    v_lshl_add_u32 v16, v8, 2, s78
    s_waitcnt vmcnt(4) lgkmcnt(14)
    v_mfma_f32_16x16x32_bf16 v[48:51], v[112:115], a[92:95], v[48:51]
    ds_read_b64_tr_b16 v[96:97], v68 offset:12288
    ds_read_b64_tr_b16 v[98:99], v68 offset:13312
    s_waitcnt lgkmcnt(14)
    v_mfma_f32_16x16x32_bf16 v[52:55], v[116:119], a[92:95], v[52:55]
    ds_read_b64_tr_b16 v[100:101], v69 offset:12288
    ds_read_b64_tr_b16 v[102:103], v69 offset:13312
    s_waitcnt lgkmcnt(14)
    v_mfma_f32_16x16x32_bf16 v[56:59], v[120:123], a[92:95], v[56:59]
    ds_read_b64_tr_b16 v[104:105], v70 offset:12288
    ds_read_b64_tr_b16 v[106:107], v70 offset:13312
    s_waitcnt lgkmcnt(14)
    v_mfma_f32_16x16x32_bf16 v[60:63], v[124:127], a[92:95], v[60:63]
    ds_read_b64_tr_b16 v[108:109], v71 offset:12288
    ds_read_b64_tr_b16 v[110:111], v71 offset:13312
    s_waitcnt vmcnt(3) lgkmcnt(14)
    v_mfma_f32_16x16x32_bf16 v[48:51], v[128:131], a[96:99], v[48:51]
    ds_read_b64_tr_b16 v[112:113], v68 offset:20480
    ds_read_b64_tr_b16 v[114:115], v68 offset:21504
    s_waitcnt lgkmcnt(14)
    v_mfma_f32_16x16x32_bf16 v[52:55], v[132:135], a[96:99], v[52:55]
    ds_read_b64_tr_b16 v[116:117], v69 offset:20480
    ds_read_b64_tr_b16 v[118:119], v69 offset:21504
    s_waitcnt lgkmcnt(14)
    v_mfma_f32_16x16x32_bf16 v[56:59], v[136:139], a[96:99], v[56:59]
    ds_read_b64_tr_b16 v[120:121], v70 offset:20480
    ds_read_b64_tr_b16 v[122:123], v70 offset:21504
    s_waitcnt lgkmcnt(14)
    v_mfma_f32_16x16x32_bf16 v[60:63], v[140:143], a[96:99], v[60:63]
    ds_read_b64_tr_b16 v[124:125], v71 offset:20480
    ds_read_b64_tr_b16 v[126:127], v71 offset:21504
    s_waitcnt vmcnt(2) lgkmcnt(14)
    v_mfma_f32_16x16x32_bf16 v[48:51], v[96:99], a[100:103], v[48:51]
    ds_read_b64_tr_b16 v[128:129], v68 offset:28672
    ds_read_b64_tr_b16 v[130:131], v68 offset:29696
    s_waitcnt lgkmcnt(14)
    v_mfma_f32_16x16x32_bf16 v[52:55], v[100:103], a[100:103], v[52:55]
    ds_read_b64_tr_b16 v[132:133], v69 offset:28672
    ds_read_b64_tr_b16 v[134:135], v69 offset:29696
    s_waitcnt lgkmcnt(14)
    v_mfma_f32_16x16x32_bf16 v[56:59], v[104:107], a[100:103], v[56:59]
    ds_read_b64_tr_b16 v[136:137], v70 offset:28672
    ds_read_b64_tr_b16 v[138:139], v70 offset:29696
    s_waitcnt lgkmcnt(14)
    v_mfma_f32_16x16x32_bf16 v[60:63], v[108:111], a[100:103], v[60:63]
    ds_read_b64_tr_b16 v[140:141], v71 offset:28672
    ds_read_b64_tr_b16 v[142:143], v71 offset:29696
    s_waitcnt vmcnt(1) lgkmcnt(14)
    v_mfma_f32_16x16x32_bf16 v[48:51], v[112:115], a[104:107], v[48:51]
    s_cmp_eq_u32 s46, 0
    s_mov_b32 s79, 114688
    s_waitcnt lgkmcnt(12)
    v_mfma_f32_16x16x32_bf16 v[52:55], v[116:119], a[104:107], v[52:55]
    s_cselect_b32 s79, s79, 4294852608
    s_add_u32 s79, s79, s63
    s_waitcnt lgkmcnt(10)
    v_mfma_f32_16x16x32_bf16 v[56:59], v[120:123], a[104:107], v[56:59]
    buffer_load_dwordx4 v[84:87], v7, s[16:19], s79 offen offset:0 sc1
    buffer_load_dwordx4 v[88:91], v7, s[16:19], s79 offen offset:1024 sc1
    s_waitcnt lgkmcnt(8)
    v_mfma_f32_16x16x32_bf16 v[60:63], v[124:127], a[104:107], v[60:63]
    buffer_load_dwordx4 v[92:95], v7, s[16:19], s79 offen offset:2048 sc1
    s_waitcnt vmcnt(3) lgkmcnt(6)
    v_mfma_f32_16x16x32_bf16 v[48:51], v[128:131], a[108:111], v[48:51]
    s_waitcnt lgkmcnt(4)
    v_mfma_f32_16x16x32_bf16 v[52:55], v[132:135], a[108:111], v[52:55]
    s_waitcnt lgkmcnt(2)
    v_mfma_f32_16x16x32_bf16 v[56:59], v[136:139], a[108:111], v[56:59]
    s_waitcnt lgkmcnt(0)
    v_mfma_f32_16x16x32_bf16 v[60:63], v[140:143], a[108:111], v[60:63]
    s_barrier
    ds_read_b32 v13, v16
    ds_read_b128 v[64:67], v15 offset:0
    ds_read_b128 v[68:71], v15 offset:1024
    ds_read_b128 v[72:75], v15 offset:2048
    ds_read_b128 v[76:79], v15 offset:3072
    s_waitcnt vmcnt(2)
    v_subrev_u32 v87, s73, v87
    s_waitcnt vmcnt(1)
    v_subrev_u32 v91, s73, v91
    s_waitcnt vmcnt(0)
    v_subrev_u32 v95, s73, v95
    v_max_u32 v87, v87, v91
    v_max_u32 v87, v87, v95
    v_cmp_le_u32 vcc, 1, v87
    s_nop 0
    s_cmp_eq_u64 vcc, 0
    s_cbranch_scc1 L_pd13
    s_mov_b32 s96, 300000
L_pl13:
    s_sleep 10
    buffer_load_dwordx4 v[84:87], v7, s[16:19], s79 offen offset:0 sc1
    buffer_load_dwordx4 v[88:91], v7, s[16:19], s79 offen offset:1024 sc1
    buffer_load_dwordx4 v[92:95], v7, s[16:19], s79 offen offset:2048 sc1
    s_waitcnt vmcnt(0)
    v_subrev_u32 v87, s73, v87
    v_subrev_u32 v91, s73, v91
    v_subrev_u32 v95, s73, v95
    v_max_u32 v87, v87, v91
    v_max_u32 v87, v87, v95
    v_cmp_le_u32 vcc, 1, v87
    s_sub_u32 s96, s96, 1
    s_cmp_eq_u32 s96, 0
    s_cbranch_scc1 L_pd13
    s_cmp_eq_u64 vcc, 0
    s_cbranch_scc0 L_pl13
L_pd13:
    v_lshlrev_b32 v32, 16, v84
    v_and_b32 v33, 0xffff0000, v84
    v_lshlrev_b32 v34, 16, v85
    v_and_b32 v35, 0xffff0000, v85
    v_lshlrev_b32 v36, 16, v86
    v_and_b32 v37, 0xffff0000, v86
    v_lshlrev_b32 v38, 16, v88
    v_and_b32 v39, 0xffff0000, v88
    v_lshlrev_b32 v40, 16, v89
    v_and_b32 v41, 0xffff0000, v89
    v_lshlrev_b32 v42, 16, v90
    v_and_b32 v43, 0xffff0000, v90
    v_lshlrev_b32 v44, 16, v92
    v_and_b32 v45, 0xffff0000, v92
    v_lshlrev_b32 v46, 16, v93
    v_and_b32 v47, 0xffff0000, v93
    v_add_f32 v48, v48, v32
    v_add_f32 v49, v49, v33
    v_add_f32 v50, v50, v34
    v_add_f32 v51, v51, v35
    v_add_f32 v52, v52, v36
    v_add_f32 v53, v53, v37
    v_add_f32 v54, v54, v38
    v_add_f32 v55, v55, v39
    v_add_f32 v56, v56, v40
    v_add_f32 v57, v57, v41
    v_add_f32 v58, v58, v42
    v_add_f32 v59, v59, v43
    v_add_f32 v60, v60, v44
    v_add_f32 v61, v61, v45
    v_add_f32 v62, v62, v46
    v_add_f32 v63, v63, v47
    s_waitcnt lgkmcnt(4)
    v_sub_f32 v13, 1.0, v13
    s_waitcnt lgkmcnt(3)
    v_fmac_f32 v64, v13, v48
    v_fmac_f32 v65, v13, v49
    v_fmac_f32 v66, v13, v50
    v_fmac_f32 v67, v13, v51
    s_waitcnt lgkmcnt(2)
    v_fmac_f32 v68, v13, v52
    v_fmac_f32 v69, v13, v53
    v_fmac_f32 v70, v13, v54
    v_fmac_f32 v71, v13, v55
    s_waitcnt lgkmcnt(1)
    v_fmac_f32 v72, v13, v56
    v_fmac_f32 v73, v13, v57
    v_fmac_f32 v74, v13, v58
    v_fmac_f32 v75, v13, v59
    s_waitcnt lgkmcnt(0)
    v_fmac_f32 v76, v13, v60
    v_fmac_f32 v77, v13, v61
    v_fmac_f32 v78, v13, v62
    v_fmac_f32 v79, v13, v63
    v_cvt_pk_bf16_f32 v80, v64, v65
    v_cvt_pk_bf16_f32 v81, v66, v67
    v_cvt_pk_bf16_f32 v82, v68, v69
    v_cvt_pk_bf16_f32 v83, v70, v71
    v_cvt_pk_bf16_f32 v84, v72, v73
    v_cvt_pk_bf16_f32 v85, v74, v75
    v_cvt_pk_bf16_f32 v86, v76, v77
    v_cvt_pk_bf16_f32 v87, v78, v79
    v_permlane16_swap_b32 v80, v82
    v_permlane16_swap_b32 v81, v83
    v_permlane16_swap_b32 v84, v86
    v_permlane16_swap_b32 v85, v87
    buffer_store_dwordx4 v[80:83], v14, s[28:31], s66 offen offset:0 sc1
    buffer_store_dwordx4 v[84:87], v14, s[28:31], s66 offen offset:64 sc1
    s_or_b32 s77, s2, s72
    s_cmp_lg_u32 s77, 0
    s_cbranch_scc1 L_fin
    v_mov_b32 v2, s75
    s_mov_b64 exec, 1
    buffer_store_dword v2, off, s[16:19], 0 sc1
    s_mov_b64 exec, -1
L_fin:
    s_endpgm
L_fft:
    s_setprio 2
    v_mov_b32 v28, 0
    ds_write_b32 v26, v28 offset:0
    ds_write_b32 v26, v28 offset:16
    ds_write_b32 v26, v28 offset:32
    ds_write_b32 v26, v28 offset:48
    v_lshrrev_b32 v32, 1, v6
    s_lshl_b32 s77, s45, 4
    v_add_u32 v32, s77, v32
    v_and_b32 v33, 1, v1
    v_cvt_f32_u32 v34, v33
    v_mul_f32 v34, 0x3e800000, v34
    v_lshl_add_u32 v35, v32, 1, v33
    v_cmp_eq_u32 vcc, 1, v35
    v_mov_b32 v35, 224
    s_nop 0
    v_cndmask_b32 v32, v32, v35, vcc
    v_cndmask_b32 v34, v34, v28, vcc
    v_cvt_f32_u32 v32, v32
    v_mul_f32 v32, 0x3b124925, v32
    s_mul_i32 s77, s72, 112
    v_lshl_add_u32 v35, v5, 3, s77
    v_cvt_f32_u32 v35, v35
    v_fmac_f32 v34, v32, v35
    v_fract_f32 v34, v34
    s_mul_i32 s77, s72, 7168
    s_add_u32 s77, s77, 122880
    v_add_u32 v35, s77, v7
    v_fmamk_f32 v40, v32, 0x00000000, v34
    v_fmamk_f32 v41, v32, 0x3f800000, v34
    v_fmamk_f32 v42, v32, 0x40000000, v34
    v_fmamk_f32 v43, v32, 0x40400000, v34
    v_fmamk_f32 v44, v32, 0x40800000, v34
    v_fmamk_f32 v45, v32, 0x40a00000, v34
    v_fmamk_f32 v46, v32, 0x40c00000, v34
    v_fmamk_f32 v47, v32, 0x40e00000, v34
    v_cos_f32 v40, v40
    v_cos_f32 v41, v41
    v_cos_f32 v42, v42
    v_cos_f32 v43, v43
    v_cos_f32 v44, v44
    v_cos_f32 v45, v45
    v_cos_f32 v46, v46
    v_cos_f32 v47, v47
    v_cvt_pk_bf16_f32 v48, v40, v41
    v_cvt_pk_bf16_f32 v49, v42, v43
    v_cvt_pk_bf16_f32 v50, v44, v45
    v_cvt_pk_bf16_f32 v51, v46, v47
    ds_write_b128 v35, v[48:51] offset:0
    v_fmamk_f32 v52, v32, 0x41800000, v34
    v_fmamk_f32 v53, v32, 0x41880000, v34
    v_fmamk_f32 v54, v32, 0x41900000, v34
    v_fmamk_f32 v55, v32, 0x41980000, v34
    v_fmamk_f32 v56, v32, 0x41a00000, v34
    v_fmamk_f32 v57, v32, 0x41a80000, v34
    v_fmamk_f32 v58, v32, 0x41b00000, v34
    v_fmamk_f32 v59, v32, 0x41b80000, v34
    v_cos_f32 v52, v52
    v_cos_f32 v53, v53
    v_cos_f32 v54, v54
    v_cos_f32 v55, v55
    v_cos_f32 v56, v56
    v_cos_f32 v57, v57
    v_cos_f32 v58, v58
    v_cos_f32 v59, v59
    v_cvt_pk_bf16_f32 v60, v52, v53
    v_cvt_pk_bf16_f32 v61, v54, v55
    v_cvt_pk_bf16_f32 v62, v56, v57
    v_cvt_pk_bf16_f32 v63, v58, v59
    ds_write_b128 v35, v[60:63] offset:1024
    v_fmamk_f32 v40, v32, 0x42000000, v34
    v_fmamk_f32 v41, v32, 0x42040000, v34
    v_fmamk_f32 v42, v32, 0x42080000, v34
    v_fmamk_f32 v43, v32, 0x420c0000, v34
    v_fmamk_f32 v44, v32, 0x42100000, v34
    v_fmamk_f32 v45, v32, 0x42140000, v34
    v_fmamk_f32 v46, v32, 0x42180000, v34
    v_fmamk_f32 v47, v32, 0x421c0000, v34
    v_cos_f32 v40, v40
    v_cos_f32 v41, v41
    v_cos_f32 v42, v42
    v_cos_f32 v43, v43
    v_cos_f32 v44, v44
    v_cos_f32 v45, v45
    v_cos_f32 v46, v46
    v_cos_f32 v47, v47
    v_cvt_pk_bf16_f32 v48, v40, v41
    v_cvt_pk_bf16_f32 v49, v42, v43
    v_cvt_pk_bf16_f32 v50, v44, v45
    v_cvt_pk_bf16_f32 v51, v46, v47
    ds_write_b128 v35, v[48:51] offset:2048
    v_fmamk_f32 v52, v32, 0x42400000, v34
    v_fmamk_f32 v53, v32, 0x42440000, v34
    v_fmamk_f32 v54, v32, 0x42480000, v34
    v_fmamk_f32 v55, v32, 0x424c0000, v34
    v_fmamk_f32 v56, v32, 0x42500000, v34
    v_fmamk_f32 v57, v32, 0x42540000, v34
    v_fmamk_f32 v58, v32, 0x42580000, v34
    v_fmamk_f32 v59, v32, 0x425c0000, v34
    v_cos_f32 v52, v52
    v_cos_f32 v53, v53
    v_cos_f32 v54, v54
    v_cos_f32 v55, v55
    v_cos_f32 v56, v56
    v_cos_f32 v57, v57
    v_cos_f32 v58, v58
    v_cos_f32 v59, v59
    v_cvt_pk_bf16_f32 v60, v52, v53
    v_cvt_pk_bf16_f32 v61, v54, v55
    v_cvt_pk_bf16_f32 v62, v56, v57
    v_cvt_pk_bf16_f32 v63, v58, v59
    ds_write_b128 v35, v[60:63] offset:3072
    v_fmamk_f32 v40, v32, 0x42800000, v34
    v_fmamk_f32 v41, v32, 0x42820000, v34
    v_fmamk_f32 v42, v32, 0x42840000, v34
    v_fmamk_f32 v43, v32, 0x42860000, v34
    v_fmamk_f32 v44, v32, 0x42880000, v34
    v_fmamk_f32 v45, v32, 0x428a0000, v34
    v_fmamk_f32 v46, v32, 0x428c0000, v34
    v_fmamk_f32 v47, v32, 0x428e0000, v34
    v_cos_f32 v40, v40
    v_cos_f32 v41, v41
    v_cos_f32 v42, v42
    v_cos_f32 v43, v43
    v_cos_f32 v44, v44
    v_cos_f32 v45, v45
    v_cos_f32 v46, v46
    v_cos_f32 v47, v47
    v_cvt_pk_bf16_f32 v48, v40, v41
    v_cvt_pk_bf16_f32 v49, v42, v43
    v_cvt_pk_bf16_f32 v50, v44, v45
    v_cvt_pk_bf16_f32 v51, v46, v47
    ds_write_b128 v35, v[48:51] offset:4096
    v_fmamk_f32 v52, v32, 0x42a00000, v34
    v_fmamk_f32 v53, v32, 0x42a20000, v34
    v_fmamk_f32 v54, v32, 0x42a40000, v34
    v_fmamk_f32 v55, v32, 0x42a60000, v34
    v_fmamk_f32 v56, v32, 0x42a80000, v34
    v_fmamk_f32 v57, v32, 0x42aa0000, v34
    v_fmamk_f32 v58, v32, 0x42ac0000, v34
    v_fmamk_f32 v59, v32, 0x42ae0000, v34
    v_cos_f32 v52, v52
    v_cos_f32 v53, v53
    v_cos_f32 v54, v54
    v_cos_f32 v55, v55
    v_cos_f32 v56, v56
    v_cos_f32 v57, v57
    v_cos_f32 v58, v58
    v_cos_f32 v59, v59
    v_cvt_pk_bf16_f32 v60, v52, v53
    v_cvt_pk_bf16_f32 v61, v54, v55
    v_cvt_pk_bf16_f32 v62, v56, v57
    v_cvt_pk_bf16_f32 v63, v58, v59
    ds_write_b128 v35, v[60:63] offset:5120
    v_fmamk_f32 v40, v32, 0x42c00000, v34
    v_fmamk_f32 v41, v32, 0x42c20000, v34
    v_fmamk_f32 v42, v32, 0x42c40000, v34
    v_fmamk_f32 v43, v32, 0x42c60000, v34
    v_fmamk_f32 v44, v32, 0x42c80000, v34
    v_fmamk_f32 v45, v32, 0x42ca0000, v34
    v_fmamk_f32 v46, v32, 0x42cc0000, v34
    v_fmamk_f32 v47, v32, 0x42ce0000, v34
    v_cos_f32 v40, v40
    v_cos_f32 v41, v41
    v_cos_f32 v42, v42
    v_cos_f32 v43, v43
    v_cos_f32 v44, v44
    v_cos_f32 v45, v45
    v_cos_f32 v46, v46
    v_cos_f32 v47, v47
    v_cvt_pk_bf16_f32 v48, v40, v41
    v_cvt_pk_bf16_f32 v49, v42, v43
    v_cvt_pk_bf16_f32 v50, v44, v45
    v_cvt_pk_bf16_f32 v51, v46, v47
    ds_write_b128 v35, v[48:51] offset:6144
    s_waitcnt lgkmcnt(0)
    s_mov_b32 s77, s3
    s_lshl_b32 s8, s77, 12
    s_add_u32 s77, s77, 1
    s_cmp_eq_u32 s77, 7
    s_cselect_b32 s77, 0, s77
    s_lshl_b32 s9, s77, 12
    s_add_u32 s77, s77, 1
    s_cmp_eq_u32 s77, 7
    s_cselect_b32 s77, 0, s77
    s_lshl_b32 s10, s77, 12
    s_add_u32 s77, s77, 1
    s_cmp_eq_u32 s77, 7
    s_cselect_b32 s77, 0, s77
    s_lshl_b32 s11, s77, 12
    s_add_u32 s77, s77, 1
    s_cmp_eq_u32 s77, 7
    s_cselect_b32 s77, 0, s77
    s_lshl_b32 s12, s77, 12
    s_add_u32 s77, s77, 1
    s_cmp_eq_u32 s77, 7
    s_cselect_b32 s77, 0, s77
    s_lshl_b32 s13, s77, 12
    s_add_u32 s77, s77, 1
    s_cmp_eq_u32 s77, 7
    s_cselect_b32 s77, 0, s77
    s_lshl_b32 s14, s77, 12
    s_mov_b32 s16, s70
    s_mov_b32 s17, s71
    s_mov_b32 s18, 16252928
    s_mov_b32 s19, 0x20000
    s_mov_b32 s20, s50
    s_mov_b32 s21, s51
    s_mov_b32 s22, 921600
    s_mov_b32 s23, 0x20000
    s_mov_b32 s24, s52
    s_mov_b32 s25, s53
    s_mov_b32 s26, 921600
    s_mov_b32 s27, 0x20000
    s_mov_b32 s40, s62
    s_mov_b32 s41, s63
    s_mov_b32 s42, 896
    s_mov_b32 s43, 0x20000
    s_lshl_b32 s50, s72, 12
    v_add_u32 v13, 122880, v7
    v_bfe_u32 v9, v1, 1, 3
    v_xor_b32 v9, v9, v5
    v_lshlrev_b32 v9, 4, v9
    v_lshl_add_u32 v9, v6, 7, v9
    v_add_u32 v9, s50, v9
    v_xor_b32 v10, 32, v9
    v_xor_b32 v11, 64, v9
    v_xor_b32 v12, 96, v9
    v_and_b32 v21, 1, v1
    v_lshlrev_b32 v22, 1, v21
    v_lshlrev_b32 v21, 31, v21
    v_or_b32 v21, 1.0, v21
    v_lshrrev_b32 v14, 1, v6
    v_lshl_add_u32 v22, v14, 4, v22
    v_lshl_add_u32 v22, v5, 10, v22
    s_lshl_b32 s77, s72, 2
    s_add_u32 s77, s77, 151552
    v_add_u32 v22, s77, v22
    s_lshl_b32 s77, s72, 11
    s_add_u32 s77, s77, 151552
    v_add_u32 v15, s77, v7
    v_lshlrev_b32 v16, 4, v8
    v_lshl_add_u32 v16, v4, 12, v16
    s_lshl_b32 s55, s45, 17
    s_add_u32 s55, s55, 1048576
    s_lshl_b32 s58, s72, 15
    s_lshl_b32 s78, s44, 8
    s_add_u32 s58, s58, s78
    s_add_u32 s58, s58, s55
    s_add_u32 s59, s58, 16384
    v_cvt_f32_u32 v32, v6
    v_mul_f32 v32, 0x3d000000, v32
    v_mul_u32_u24 v33, s76, v8
    v_bfe_u32 v34, v1, 4, 1
    s_lshr_b32 s79, s76, 5
    s_lshl_b32 s79, s79, 9
    v_mad_u32_u24 v33, v34, s79, v33
    v_cvt_f32_u32 v33, v33
    v_mul_f32 v33, 0x3a000000, v33
    v_lshlrev_b32 v34, 3, v5
    v_cvt_f32_u32 v34, v34
    v_fmac_f32 v33, v32, v34
    v_fmamk_f32 v36, v32, 0x00000000, v33
    v_fmamk_f32 v37, v32, 0x40000000, v33
    v_fmamk_f32 v38, v32, 0x40800000, v33
    v_fmamk_f32 v39, v32, 0x40c00000, v33
    v_sin_f32 v40, v36
    v_cos_f32 v36, v36
    v_sin_f32 v41, v37
    v_cos_f32 v37, v37
    v_sin_f32 v42, v38
    v_cos_f32 v38, v38
    v_sin_f32 v43, v39
    v_cos_f32 v39, v39
    v_cvt_pk_bf16_f32 v128, v36, v37
    v_cvt_pk_bf16_f32 v136, v40, v41
    v_cvt_pk_bf16_f32 v129, v38, v39
    v_cvt_pk_bf16_f32 v137, v42, v43
    v_fmamk_f32 v36, v32, 0x41800000, v33
    v_fmamk_f32 v37, v32, 0x41900000, v33
    v_fmamk_f32 v38, v32, 0x41a00000, v33
    v_fmamk_f32 v39, v32, 0x41b00000, v33
    v_sin_f32 v40, v36
    v_cos_f32 v36, v36
    v_sin_f32 v41, v37
    v_cos_f32 v37, v37
    v_sin_f32 v42, v38
    v_cos_f32 v38, v38
    v_sin_f32 v43, v39
    v_cos_f32 v39, v39
    v_cvt_pk_bf16_f32 v130, v36, v37
    v_cvt_pk_bf16_f32 v138, v40, v41
    v_cvt_pk_bf16_f32 v131, v38, v39
    v_cvt_pk_bf16_f32 v139, v42, v43
    v_fmamk_f32 v36, v32, 0x3f800000, v33
    v_fmamk_f32 v37, v32, 0x40400000, v33
    v_fmamk_f32 v38, v32, 0x40a00000, v33
    v_fmamk_f32 v39, v32, 0x40e00000, v33
    v_sin_f32 v40, v36
    v_cos_f32 v36, v36
    v_sin_f32 v41, v37
    v_cos_f32 v37, v37
    v_sin_f32 v42, v38
    v_cos_f32 v38, v38
    v_sin_f32 v43, v39
    v_cos_f32 v39, v39
    v_cvt_pk_bf16_f32 v132, v36, v37
    v_cvt_pk_bf16_f32 v140, v40, v41
    v_cvt_pk_bf16_f32 v133, v38, v39
    v_cvt_pk_bf16_f32 v141, v42, v43
    v_fmamk_f32 v36, v32, 0x41880000, v33
    v_fmamk_f32 v37, v32, 0x41980000, v33
    v_fmamk_f32 v38, v32, 0x41a80000, v33
    v_fmamk_f32 v39, v32, 0x41b80000, v33
    v_sin_f32 v40, v36
    v_cos_f32 v36, v36
    v_sin_f32 v41, v37
    v_cos_f32 v37, v37
    v_sin_f32 v42, v38
    v_cos_f32 v38, v38
    v_sin_f32 v43, v39
    v_cos_f32 v39, v39
    s_waitcnt vmcnt(0)
    v_cvt_pk_bf16_f32 v134, v36, v37
    v_cvt_pk_bf16_f32 v142, v40, v41
    v_cvt_pk_bf16_f32 v135, v38, v39
    v_cvt_pk_bf16_f32 v143, v42, v43
    s_barrier
    v_add_u32 v23, s8, v13
    ds_read_b128 a[0:3], v23 offset:0
    ds_read_b128 a[4:7], v23 offset:1024
    ds_read_b128 a[8:11], v23 offset:2048
    ds_read_b128 a[12:15], v23 offset:3072
    v_add_u32 v23, s9, v13
    ds_read_b128 a[16:19], v23 offset:0
    ds_read_b128 a[20:23], v23 offset:1024
    ds_read_b128 a[24:27], v23 offset:2048
    ds_read_b128 a[28:31], v23 offset:3072
    v_add_u32 v23, s10, v13
    ds_read_b128 a[32:35], v23 offset:0
    ds_read_b128 a[36:39], v23 offset:1024
    ds_read_b128 a[40:43], v23 offset:2048
    ds_read_b128 a[44:47], v23 offset:3072
    v_add_u32 v23, s11, v13
    ds_read_b128 a[48:51], v23 offset:0
    ds_read_b128 a[52:55], v23 offset:1024
    ds_read_b128 a[56:59], v23 offset:2048
    ds_read_b128 a[60:63], v23 offset:3072
    v_add_u32 v23, s12, v13
    ds_read_b128 a[64:67], v23 offset:0
    ds_read_b128 a[68:71], v23 offset:1024
    ds_read_b128 a[72:75], v23 offset:2048
    ds_read_b128 a[76:79], v23 offset:3072
    v_add_u32 v23, s13, v13
    ds_read_b128 a[80:83], v23 offset:0
    ds_read_b128 a[84:87], v23 offset:1024
    ds_read_b128 a[88:91], v23 offset:2048
    ds_read_b128 a[92:95], v23 offset:3072
    v_add_u32 v23, s14, v13
    ds_read_b128 a[96:99], v23 offset:0
    ds_read_b128 a[100:103], v23 offset:1024
    ds_read_b128 a[104:107], v23 offset:2048
    ds_read_b128 a[108:111], v23 offset:3072
    ds_read_b32 v28, v26 offset:48
    s_waitcnt lgkmcnt(0)
    v_cmp_gt_u32 vcc, 1, v28
    s_nop 0
    s_cmp_eq_u64 vcc, 0
    s_cbranch_scc1 L_pd14
    s_mov_b32 s96, 300000
L_pl14:
    s_sleep 1
    ds_read_b32 v28, v26 offset:48
    s_waitcnt lgkmcnt(0)
    v_cmp_gt_u32 vcc, 1, v28
    s_sub_u32 s96, s96, 1
    s_cmp_eq_u32 s96, 0
    s_cbranch_scc1 L_pd14
    s_cmp_eq_u64 vcc, 0
    s_cbranch_scc0 L_pl14
L_pd14:
    ds_read_b128 v[48:51], v9 offset:0
    ds_read_b128 v[52:55], v10 offset:0
    ds_read_b128 v[56:59], v11 offset:0
    ds_read_b128 v[60:63], v12 offset:0
    ds_read_b128 v[64:67], v9 offset:16384
    ds_read_b128 v[68:71], v10 offset:16384
    ds_read_b128 v[72:75], v11 offset:16384
    ds_read_b128 v[76:79], v12 offset:16384
    s_waitcnt lgkmcnt(7)
    v_mfma_f32_32x32x16_bf16 v[80:95], v[48:51], a[0:3], 0
    ds_read_b128 v[96:99], v9 offset:32768
    ds_read_b128 v[100:103], v10 offset:32768
    s_waitcnt lgkmcnt(8)
    v_mfma_f32_32x32x16_bf16 v[80:95], v[52:55], a[4:7], v[80:95]
    ds_read_b128 v[104:107], v11 offset:32768
    ds_read_b128 v[108:111], v12 offset:32768
    s_waitcnt lgkmcnt(9)
    v_mfma_f32_32x32x16_bf16 v[80:95], v[56:59], a[8:11], v[80:95]
    ds_read_b128 v[112:115], v9 offset:49152
    ds_read_b128 v[116:119], v10 offset:49152
    s_waitcnt lgkmcnt(10)
    v_mfma_f32_32x32x16_bf16 v[80:95], v[60:63], a[12:15], v[80:95]
    ds_read_b128 v[120:123], v11 offset:49152
    ds_read_b128 v[124:127], v12 offset:49152
    ds_read_b128 v[28:31], v27 offset:48
    v_add_u32 v9, 65536, v9
    v_add_u32 v10, 65536, v10
    v_add_u32 v11, 65536, v11
    v_add_u32 v12, 65536, v12
    s_waitcnt lgkmcnt(12)
    v_mfma_f32_32x32x16_bf16 v[80:95], v[64:67], a[16:19], v[80:95]
    s_waitcnt lgkmcnt(11)
    v_mfma_f32_32x32x16_bf16 v[80:95], v[68:71], a[20:23], v[80:95]
    s_waitcnt lgkmcnt(10)
    v_mfma_f32_32x32x16_bf16 v[80:95], v[72:75], a[24:27], v[80:95]
    s_waitcnt lgkmcnt(9)
    v_mfma_f32_32x32x16_bf16 v[80:95], v[76:79], a[28:31], v[80:95]
    s_waitcnt lgkmcnt(1)
    v_mov_b32 v47, 4
    ds_write_b32 v26, v47 offset:16
    s_waitcnt lgkmcnt(1)
    v_min_u32 v28, v28, v29
    v_min3_u32 v28, v28, v30, v31
    v_cmp_gt_u32 vcc, 2, v28
    s_nop 0
    s_cmp_eq_u64 vcc, 0
    s_cbranch_scc1 L_pd15
    s_mov_b32 s96, 300000
L_pl15:
    s_sleep 1
    ds_read_b128 v[28:31], v27 offset:48
    s_waitcnt lgkmcnt(0)
    v_min_u32 v28, v28, v29
    v_min3_u32 v28, v28, v30, v31
    v_cmp_gt_u32 vcc, 2, v28
    s_sub_u32 s96, s96, 1
    s_cmp_eq_u32 s96, 0
    s_cbranch_scc1 L_pd15
    s_cmp_eq_u64 vcc, 0
    s_cbranch_scc0 L_pl15
L_pd15:
    v_mfma_f32_32x32x16_bf16 v[80:95], v[96:99], a[32:35], v[80:95]
    ds_read_b128 v[48:51], v9 offset:0
    ds_read_b128 v[52:55], v10 offset:0
    v_mfma_f32_32x32x16_bf16 v[80:95], v[100:103], a[36:39], v[80:95]
    ds_read_b128 v[56:59], v11 offset:0
    ds_read_b128 v[60:63], v12 offset:0
    v_mfma_f32_32x32x16_bf16 v[80:95], v[104:107], a[40:43], v[80:95]
    ds_read_b128 v[64:67], v9 offset:16384
    ds_read_b128 v[68:71], v10 offset:16384
    v_mfma_f32_32x32x16_bf16 v[80:95], v[108:111], a[44:47], v[80:95]
    ds_read_b128 v[72:75], v11 offset:16384
    ds_read_b128 v[76:79], v12 offset:16384
    v_mfma_f32_32x32x16_bf16 v[80:95], v[112:115], a[48:51], v[80:95]
    ds_read_b128 v[96:99], v9 offset:32768
    v_mfma_f32_32x32x16_bf16 v[80:95], v[116:119], a[52:55], v[80:95]
    ds_read_b128 v[100:103], v10 offset:32768
    v_mfma_f32_32x32x16_bf16 v[80:95], v[120:123], a[56:59], v[80:95]
    ds_read_b128 v[104:107], v11 offset:32768
    v_mfma_f32_32x32x16_bf16 v[80:95], v[124:127], a[60:63], v[80:95]
    ds_read_b128 v[108:111], v12 offset:32768
    s_waitcnt lgkmcnt(11)
    v_mfma_f32_32x32x16_bf16 v[80:95], v[48:51], a[64:67], v[80:95]
    s_waitcnt lgkmcnt(10)
    v_mfma_f32_32x32x16_bf16 v[80:95], v[52:55], a[68:71], v[80:95]
    s_waitcnt lgkmcnt(9)
    v_mfma_f32_32x32x16_bf16 v[80:95], v[56:59], a[72:75], v[80:95]
    s_waitcnt lgkmcnt(8)
    v_mfma_f32_32x32x16_bf16 v[80:95], v[60:63], a[76:79], v[80:95]
    s_waitcnt lgkmcnt(7)
    v_mfma_f32_32x32x16_bf16 v[80:95], v[64:67], a[80:83], v[80:95]
    s_waitcnt lgkmcnt(6)
    v_mfma_f32_32x32x16_bf16 v[80:95], v[68:71], a[84:87], v[80:95]
    s_waitcnt lgkmcnt(5)
    v_mfma_f32_32x32x16_bf16 v[80:95], v[72:75], a[88:91], v[80:95]
    s_waitcnt lgkmcnt(4)
    v_mfma_f32_32x32x16_bf16 v[80:95], v[76:79], a[92:95], v[80:95]
    s_waitcnt lgkmcnt(0)
    v_mov_b32 v28, 7
    ds_write_b32 v26, v28 offset:16
    ds_read_b128 v[28:31], v27 offset:16
    v_mfma_f32_32x32x16_bf16 v[80:95], v[96:99], a[96:99], v[80:95]
    v_mfma_f32_32x32x16_bf16 v[80:95], v[100:103], a[100:103], v[80:95]
    v_mfma_f32_32x32x16_bf16 v[80:95], v[104:107], a[104:107], v[80:95]
    v_mfma_f32_32x32x16_bf16 v[80:95], v[108:111], a[108:111], v[80:95]
    s_waitcnt lgkmcnt(0)
    v_min_u32 v28, v28, v29
    v_min3_u32 v28, v28, v30, v31
    v_cmp_gt_u32 vcc, 4, v28
    s_nop 0
    s_cmp_eq_u64 vcc, 0
    s_cbranch_scc1 L_pd16
    s_mov_b32 s96, 300000
L_pl16:
    s_sleep 1
    ds_read_b128 v[28:31], v27 offset:16
    s_waitcnt lgkmcnt(0)
    v_min_u32 v28, v28, v29
    v_min3_u32 v28, v28, v30, v31
    v_cmp_gt_u32 vcc, 4, v28
    s_sub_u32 s96, s96, 1
    s_cmp_eq_u32 s96, 0
    s_cbranch_scc1 L_pd16
    s_cmp_eq_u64 vcc, 0
    s_cbranch_scc0 L_pl16
L_pd16:
    buffer_load_dword v24, off, s[16:19], 0 sc1
    s_nop 3
    v_cvt_pk_bf16_f32 v80, v80, v81
    v_cvt_pk_bf16_f32 v81, v82, v83
    v_cvt_pk_bf16_f32 v82, v84, v85
    v_cvt_pk_bf16_f32 v83, v86, v87
    v_cvt_pk_bf16_f32 v84, v88, v89
    v_cvt_pk_bf16_f32 v85, v90, v91
    v_cvt_pk_bf16_f32 v86, v92, v93
    v_cvt_pk_bf16_f32 v87, v94, v95
    v_mfma_f32_32x32x16_bf16 v[32:47], v[128:131], v[80:83], 0
    v_mfma_f32_32x32x16_bf16 v[48:63], v[136:139], v[80:83], 0
    v_mfma_f32_32x32x16_bf16 v[32:47], v[132:135], v[84:87], v[32:47]
    v_mfma_f32_32x32x16_bf16 v[48:63], v[140:143], v[84:87], v[48:63]
    s_cmp_lg_u32 s45, 0
    s_cbranch_scc1 L_sp1
    s_nop 9
    v_cvt_pk_bf16_f32 v64, v32, -v48
    v_cvt_pk_bf16_f32 v65, v33, -v49
    v_cvt_pk_bf16_f32 v66, v34, -v50
    v_cvt_pk_bf16_f32 v67, v35, -v51
    v_cvt_pk_bf16_f32 v68, v36, -v52
    v_cvt_pk_bf16_f32 v69, v37, -v53
    v_cvt_pk_bf16_f32 v70, v38, -v54
    v_cvt_pk_bf16_f32 v71, v39, -v55
    v_cvt_pk_bf16_f32 v72, v40, -v56
    v_cvt_pk_bf16_f32 v73, v41, -v57
    v_cvt_pk_bf16_f32 v74, v42, -v58
    v_cvt_pk_bf16_f32 v75, v43, -v59
    v_cvt_pk_bf16_f32 v76, v44, -v60
    v_cvt_pk_bf16_f32 v77, v45, -v61
    v_cvt_pk_bf16_f32 v78, v46, -v62
    v_cvt_pk_bf16_f32 v79, v47, -v63
L_sp1:
    s_nop 9
    v_fmac_f32_dpp v32, v48, v21 quad_perm:[1,0,3,2] row_mask:0xf bank_mask:0xf
    v_fmac_f32_dpp v33, v49, v21 quad_perm:[1,0,3,2] row_mask:0xf bank_mask:0xf
    v_fmac_f32_dpp v34, v50, v21 quad_perm:[1,0,3,2] row_mask:0xf bank_mask:0xf
    v_fmac_f32_dpp v35, v51, v21 quad_perm:[1,0,3,2] row_mask:0xf bank_mask:0xf
    v_fmac_f32_dpp v36, v52, v21 quad_perm:[1,0,3,2] row_mask:0xf bank_mask:0xf
    v_fmac_f32_dpp v37, v53, v21 quad_perm:[1,0,3,2] row_mask:0xf bank_mask:0xf
    v_fmac_f32_dpp v38, v54, v21 quad_perm:[1,0,3,2] row_mask:0xf bank_mask:0xf
    v_fmac_f32_dpp v39, v55, v21 quad_perm:[1,0,3,2] row_mask:0xf bank_mask:0xf
    v_fmac_f32_dpp v40, v56, v21 quad_perm:[1,0,3,2] row_mask:0xf bank_mask:0xf
    v_fmac_f32_dpp v41, v57, v21 quad_perm:[1,0,3,2] row_mask:0xf bank_mask:0xf
    v_fmac_f32_dpp v42, v58, v21 quad_perm:[1,0,3,2] row_mask:0xf bank_mask:0xf
    v_fmac_f32_dpp v43, v59, v21 quad_perm:[1,0,3,2] row_mask:0xf bank_mask:0xf
    v_fmac_f32_dpp v44, v60, v21 quad_perm:[1,0,3,2] row_mask:0xf bank_mask:0xf
    v_fmac_f32_dpp v45, v61, v21 quad_perm:[1,0,3,2] row_mask:0xf bank_mask:0xf
    v_fmac_f32_dpp v46, v62, v21 quad_perm:[1,0,3,2] row_mask:0xf bank_mask:0xf
    v_fmac_f32_dpp v47, v63, v21 quad_perm:[1,0,3,2] row_mask:0xf bank_mask:0xf
    v_cvt_pk_bf16_f32 v48, v32, v33
    v_cvt_pk_bf16_f32 v49, v34, v35
    v_cvt_pk_bf16_f32 v50, v36, v37
    v_cvt_pk_bf16_f32 v51, v38, v39
    v_cvt_pk_bf16_f32 v52, v40, v41
    v_cvt_pk_bf16_f32 v53, v42, v43
    v_cvt_pk_bf16_f32 v54, v44, v45
    v_cvt_pk_bf16_f32 v55, v46, v47
    ds_write_b16 v22, v48 offset:0
    ds_write_b16_d16_hi v22, v48 offset:256
    ds_write_b16 v22, v49 offset:512
    ds_write_b16_d16_hi v22, v49 offset:768
    ds_write_b16 v22, v50 offset:2048
    ds_write_b16_d16_hi v22, v50 offset:2304
    ds_write_b16 v22, v51 offset:2560
    ds_write_b16_d16_hi v22, v51 offset:2816
    ds_write_b16 v22, v52 offset:4096
    ds_write_b16_d16_hi v22, v52 offset:4352
    ds_write_b16 v22, v53 offset:4608
    ds_write_b16_d16_hi v22, v53 offset:4864
    ds_write_b16 v22, v54 offset:6144
    ds_write_b16_d16_hi v22, v54 offset:6400
    ds_write_b16 v22, v55 offset:6656
    ds_write_b16_d16_hi v22, v55 offset:6912
    s_cmp_lg_u32 s45, 0
    s_cbranch_scc1 L_sp2
    v_and_b32 v23, 1, v1
    s_mov_b32 s77, 36866
    v_mul_u32_u24 v23, s77, v23
    v_sub_u32 v23, v22, v23
    s_mov_b32 exec_lo, 3
    s_mov_b32 exec_hi, 3
    ds_write_b32 v23, v64 offset:0
    ds_write_b32 v23, v65 offset:256
    ds_write_b32 v23, v66 offset:512
    ds_write_b32 v23, v67 offset:768
    ds_write_b32 v23, v68 offset:2048
    ds_write_b32 v23, v69 offset:2304
    ds_write_b32 v23, v70 offset:2560
    ds_write_b32 v23, v71 offset:2816
    ds_write_b32 v23, v72 offset:4096
    ds_write_b32 v23, v73 offset:4352
    ds_write_b32 v23, v74 offset:4608
    ds_write_b32 v23, v75 offset:4864
    ds_write_b32 v23, v76 offset:6144
    ds_write_b32 v23, v77 offset:6400
    ds_write_b32 v23, v78 offset:6656
    ds_write_b32 v23, v79 offset:6912
    s_mov_b64 exec, -1
L_sp2:
    v_mov_b32 v28, 8
    ds_write_b32 v26, v28 offset:16
    ds_read_b128 v[28:31], v27 offset:16
    s_waitcnt lgkmcnt(0)
    v_min_u32 v28, v28, v29
    v_min3_u32 v28, v28, v30, v31
    v_cmp_gt_u32 vcc, 8, v28
    s_nop 0
    s_cmp_eq_u64 vcc, 0
    s_cbranch_scc1 L_pd17
    s_mov_b32 s96, 300000
L_pl17:
    s_sleep 1
    ds_read_b128 v[28:31], v27 offset:16
    s_waitcnt lgkmcnt(0)
    v_min_u32 v28, v28, v29
    v_min3_u32 v28, v28, v30, v31
    v_cmp_gt_u32 vcc, 8, v28
    s_sub_u32 s96, s96, 1
    s_cmp_eq_u32 s96, 0
    s_cbranch_scc1 L_pd17
    s_cmp_eq_u64 vcc, 0
    s_cbranch_scc0 L_pl17
L_pd17:
    ds_read_b128 v[64:67], v15
    ds_read_b128 v[68:71], v15 offset:1024
    s_waitcnt lgkmcnt(1)
    buffer_store_dwordx4 v[64:67], v16, s[16:19], s58 offen sc1
    s_waitcnt lgkmcnt(0)
    buffer_store_dwordx4 v[68:71], v16, s[16:19], s59 offen sc1
    s_cmp_lg_u32 s45, 0
    s_cbranch_scc1 L_sp3
    s_lshl_b32 s77, s72, 11
    s_add_u32 s77, s77, 114688
    v_lshlrev_b32 v21, 8, v1
    v_add_u32 v22, s77, v21
    v_lshlrev_b32 v21, 11, v1
    s_lshl_b32 s77, s72, 14
    s_lshl_b32 s78, s44, 7
    s_add_u32 s77, s77, s78
    s_add_u32 s77, s77, 327680
    s_mov_b64 exec, 0xff
    ds_read_b128 v[72:75], v22
    s_waitcnt lgkmcnt(0)
    buffer_store_dwordx4 v[72:75], v21, s[16:19], s77 offen sc1
    s_mov_b64 exec, -1
L_sp3:
    s_waitcnt vmcnt(2)
    v_readfirstlane_b32 s77, v24
    s_nop 0
    s_add_u32 s75, s77, 1
    s_mul_i32 s77, s77, 0x9E3779B1
    s_add_u32 s73, s77, 0x7F4A7C15
    s_add_u32 s74, s73, 1
    v_mov_b32 v24, s73
    v_mov_b32 v28, 9
    ds_write_b32 v26, v28 offset:16
    v_mov_b32 v96, 0
    v_mov_b32 v97, 0
    v_mov_b32 v98, 0
    v_mov_b32 v99, 0
    v_mov_b32 v100, 0
    v_mov_b32 v101, 0
    v_mov_b32 v102, 0
    v_mov_b32 v103, 0
    v_mov_b32 v104, 0
    v_mov_b32 v105, 0
    v_mov_b32 v106, 0
    v_mov_b32 v107, 0
    v_mov_b32 v108, 0
    v_mov_b32 v109, 0
    v_mov_b32 v110, 0
    v_mov_b32 v111, 0
    v_lshlrev_b32 v19, 1, v8
    s_mov_b32 s77, 115200
    v_mad_u32_u24 v19, v4, s77, v19
    s_lshl_b32 s56, s72, 4
    s_add_u32 s56, s56, s44
    s_mul_i32 s77, s56, 450
    s_lshl_b32 s78, s45, 5
    s_add_u32 s57, s77, s78
    s_lshl_b32 s60, s45, 2
    s_add_u32 s60, s60, s72
    s_lshl_b32 s60, s60, 2
    s_and_b32 s77, s44, 3
    s_add_u32 s60, s60, s77
    s_lshl_b32 s60, s60, 3
    s_lshr_b32 s78, s44, 2
    s_add_u32 s60, s60, s78
    s_lshl_b32 s60, s60, 4
    s_add_u32 s60, s60, 4096
    s_lshl_b32 s62, s47, 2
    s_add_u32 s62, s62, s77
    s_lshl_b32 s62, s62, 1
    s_and_b32 s77, s72, 1
    s_add_u32 s62, s62, s77
    s_lshl_b32 s62, s62, 3
    s_and_b32 s77, s2, 7
    s_add_u32 s62, s62, s77
    s_lshl_b32 s62, s62, 4
    s_lshr_b32 s77, s72, 1
    s_lshl_b32 s77, s77, 13
    s_add_u32 s62, s62, s77
    s_add_u32 s62, s62, 65536
    s_lshr_b32 s77, s44, 3
    s_and_b32 s78, s72, 1
    s_lshl_b32 s79, s78, 1
    s_add_u32 s77, s77, s79
    s_lshl_b32 s79, s45, 2
    s_add_u32 s77, s77, s79
    s_lshl_b32 s77, s77, 9
    s_add_u32 s63, s77, 4096
    v_and_b32 v9, 3, v1
    v_lshlrev_b32 v9, 7, v9
    v_bfe_u32 v10, v1, 2, 2
    v_lshl_add_u32 v9, v10, 4, v9
    s_setprio 0
    v_lshl_add_u32 v32, v8, 2, s72
    v_cvt_f32_u32 v32, v32
    v_mul_f32 v32, 0x3c000000, v32
    v_lshlrev_b32 v34, 2, v4
    v_cvt_f32_u32 v34, v34
    v_mul_f32 v33, v32, v34
    v_fmamk_f32 v40, v32, 0x00000000, v33
    v_fmamk_f32 v41, v32, 0x3f800000, v33
    v_fmamk_f32 v42, v32, 0x40000000, v33
    v_fmamk_f32 v43, v32, 0x40400000, v33
    v_fmamk_f32 v44, v32, 0x41800000, v33
    v_fmamk_f32 v45, v32, 0x41880000, v33
    v_fmamk_f32 v46, v32, 0x41900000, v33
    v_fmamk_f32 v47, v32, 0x41980000, v33
    v_sin_f32 v48, v40
    v_cos_f32 v40, v40
    v_sin_f32 v49, v41
    v_cos_f32 v41, v41
    v_sin_f32 v50, v42
    v_cos_f32 v42, v42
    v_sin_f32 v51, v43
    v_cos_f32 v43, v43
    v_sin_f32 v52, v44
    v_cos_f32 v44, v44
    v_sin_f32 v53, v45
    v_cos_f32 v45, v45
    v_sin_f32 v54, v46
    v_cos_f32 v46, v46
    v_sin_f32 v55, v47
    v_cos_f32 v47, v47
    v_cvt_pk_bf16_f32 v56, v40, v48
    v_cvt_pk_bf16_f32 v60, -v48, v40
    v_accvgpr_write_b32 a0, v56
    v_accvgpr_write_b32 a16, v60
    v_cvt_pk_bf16_f32 v57, v41, v49
    v_cvt_pk_bf16_f32 v61, -v49, v41
    v_accvgpr_write_b32 a1, v57
    v_accvgpr_write_b32 a17, v61
    v_cvt_pk_bf16_f32 v58, v42, v50
    v_cvt_pk_bf16_f32 v62, -v50, v42
    v_accvgpr_write_b32 a2, v58
    v_accvgpr_write_b32 a18, v62
    v_cvt_pk_bf16_f32 v59, v43, v51
    v_cvt_pk_bf16_f32 v63, -v51, v43
    v_accvgpr_write_b32 a3, v59
    v_accvgpr_write_b32 a19, v63
    v_cvt_pk_bf16_f32 v56, v44, v52
    v_cvt_pk_bf16_f32 v60, -v52, v44
    v_accvgpr_write_b32 a4, v56
    v_accvgpr_write_b32 a20, v60
    v_cvt_pk_bf16_f32 v57, v45, v53
    v_cvt_pk_bf16_f32 v61, -v53, v45
    v_accvgpr_write_b32 a5, v57
    v_accvgpr_write_b32 a21, v61
    v_cvt_pk_bf16_f32 v58, v46, v54
    v_cvt_pk_bf16_f32 v62, -v54, v46
    v_accvgpr_write_b32 a6, v58
    v_accvgpr_write_b32 a22, v62
    v_cvt_pk_bf16_f32 v59, v47, v55
    v_cvt_pk_bf16_f32 v63, -v55, v47
    v_accvgpr_write_b32 a7, v59
    v_accvgpr_write_b32 a23, v63
    v_add_f32 v32, 0.5, v32
    v_mul_f32 v33, v32, v34
    v_fmamk_f32 v40, v32, 0x00000000, v33
    v_fmamk_f32 v41, v32, 0x3f800000, v33
    v_fmamk_f32 v42, v32, 0x40000000, v33
    v_fmamk_f32 v43, v32, 0x40400000, v33
    v_fmamk_f32 v44, v32, 0x41800000, v33
    v_fmamk_f32 v45, v32, 0x41880000, v33
    v_fmamk_f32 v46, v32, 0x41900000, v33
    v_fmamk_f32 v47, v32, 0x41980000, v33
    v_sin_f32 v48, v40
    v_cos_f32 v40, v40
    v_sin_f32 v49, v41
    v_cos_f32 v41, v41
    v_sin_f32 v50, v42
    v_cos_f32 v42, v42
    v_sin_f32 v51, v43
    v_cos_f32 v43, v43
    v_sin_f32 v52, v44
    v_cos_f32 v44, v44
    v_sin_f32 v53, v45
    v_cos_f32 v45, v45
    v_sin_f32 v54, v46
    v_cos_f32 v46, v46
    v_sin_f32 v55, v47
    v_cos_f32 v47, v47
    v_cvt_pk_bf16_f32 v56, v40, v48
    v_cvt_pk_bf16_f32 v60, -v48, v40
    s_waitcnt vmcnt(0)
    s_mov_b64 exec, 1
    buffer_store_dword v24, off, s[16:19], s60 sc1
    s_mov_b64 exec, -1
    s_setprio 0
    v_lshrrev_b32 v20, 2, v1
    v_lshlrev_b32 v20, 4, v20
    s_cmp_lg_u32 s45, 0
    s_cbranch_scc1 L_sp4
    s_lshl_b32 s65, s76, 9
    s_add_u32 s65, s65, 262144
    buffer_load_dwordx4 v[128:131], v20, s[16:19], s65 offen offset:0 sc1
    buffer_load_dwordx4 v[132:135], v20, s[16:19], s65 offen offset:256 sc1
L_sp4:
    v_accvgpr_write_b32 a8, v56
    s_add_u32 s79, s57, 0
    buffer_load_short_d16_hi v96, v19, s[20:23], s79 offen
    v_accvgpr_write_b32 a24, v60
    v_cvt_pk_bf16_f32 v57, v41, v49
    v_cvt_pk_bf16_f32 v61, -v49, v41
    buffer_load_short_d16_hi v104, v19, s[24:27], s79 offen
    v_accvgpr_write_b32 a9, v57
    v_accvgpr_write_b32 a25, v61
    v_cvt_pk_bf16_f32 v58, v42, v50
    v_cvt_pk_bf16_f32 v62, -v50, v42
    s_add_u32 s79, s57, 28800
    buffer_load_short_d16_hi v97, v19, s[20:23], s79 offen
    v_accvgpr_write_b32 a10, v58
    v_accvgpr_write_b32 a26, v62
    v_cvt_pk_bf16_f32 v59, v43, v51
    v_cvt_pk_bf16_f32 v63, -v51, v43
    buffer_load_short_d16_hi v105, v19, s[24:27], s79 offen
    v_accvgpr_write_b32 a11, v59
    v_accvgpr_write_b32 a27, v63
    v_cvt_pk_bf16_f32 v56, v44, v52
    v_cvt_pk_bf16_f32 v60, -v52, v44
    s_add_u32 s79, s57, 57600
    buffer_load_short_d16_hi v98, v19, s[20:23], s79 offen
    v_accvgpr_write_b32 a12, v56
    v_accvgpr_write_b32 a28, v60
    v_cvt_pk_bf16_f32 v57, v45, v53
    buffer_load_short_d16_hi v106, v19, s[24:27], s79 offen
    v_cvt_pk_bf16_f32 v61, -v53, v45
    v_accvgpr_write_b32 a13, v57
    v_accvgpr_write_b32 a29, v61
    v_cvt_pk_bf16_f32 v58, v46, v54
    s_add_u32 s79, s57, 86400
    buffer_load_short_d16_hi v99, v19, s[20:23], s79 offen
    v_cvt_pk_bf16_f32 v62, -v54, v46
    v_accvgpr_write_b32 a14, v58
    v_accvgpr_write_b32 a30, v62
    v_cvt_pk_bf16_f32 v59, v47, v55
    buffer_load_short_d16_hi v107, v19, s[24:27], s79 offen
    v_cvt_pk_bf16_f32 v63, -v55, v47
    v_accvgpr_write_b32 a15, v59
    v_accvgpr_write_b32 a31, v63
    s_lshl_b32 s68, s47, 6
    s_add_u32 s79, s57, 460800
    buffer_load_short_d16_hi v100, v19, s[20:23], s79 offen
    v_add_u32 v80, s68, v8
    v_cvt_f32_u32 v80, v80
    s_lshl_b32 s68, s72, 6
    buffer_load_short_d16_hi v108, v19, s[24:27], s79 offen
    v_bfe_u32 v81, v1, 4, 1
    v_lshl_add_u32 v81, v81, 1, v5
    v_lshl_add_u32 v81, v81, 4, s68
    v_cvt_f32_u32 v81, v81
    s_add_u32 s79, s57, 489600
    buffer_load_short_d16_hi v101, v19, s[20:23], s79 offen
    v_and_b32 v84, 1, v1
    v_lshlrev_b32 v84, 31, v84
    v_or_b32 v84, 0x3e803e80, v84
    v_cmp_eq_u32 s[70:71], 0, v81
    buffer_load_short_d16_hi v109, v19, s[24:27], s79 offen
    v_add_f32 v82, 0x00000000, v80
    v_mul_f32 v82, 0x3b124925, v82
    v_mul_f32 v83, v82, v81
    v_fract_f32 v83, v83
    s_add_u32 s79, s57, 518400
    buffer_load_short_d16_hi v102, v19, s[20:23], s79 offen
    v_fmamk_f32 v88, v82, 0x00000000, v83
    v_fmamk_f32 v89, v82, 0x40800000, v83
    v_fmamk_f32 v90, v82, 0x41000000, v83
    buffer_load_short_d16_hi v110, v19, s[24:27], s79 offen
    v_fmamk_f32 v91, v82, 0x41400000, v83
    v_sin_f32 v92, v88
    v_cos_f32 v88, v88
    v_sin_f32 v93, v89
    s_add_u32 s79, s57, 547200
    buffer_load_short_d16_hi v103, v19, s[20:23], s79 offen
    v_cos_f32 v89, v89
    v_sin_f32 v94, v90
    v_cos_f32 v90, v90
    v_sin_f32 v95, v91
    buffer_load_short_d16_hi v111, v19, s[24:27], s79 offen
    v_cos_f32 v91, v91
    v_cvt_pk_bf16_f32 v88, v88, -v92
    v_cvt_pk_bf16_f32 v89, v89, -v93
    v_cvt_pk_bf16_f32 v90, v90, -v94
    v_cvt_pk_bf16_f32 v91, v91, -v95
    v_cndmask_b32 v88, v88, v84, s[70:71]
    v_accvgpr_write_b32 a48, v88
    v_accvgpr_write_b32 a49, v89
    v_accvgpr_write_b32 a50, v90
    v_accvgpr_write_b32 a51, v91
    v_fmamk_f32 v88, v82, 0x3f800000, v83
    v_fmamk_f32 v89, v82, 0x40a00000, v83
    v_fmamk_f32 v90, v82, 0x41100000, v83
    v_fmamk_f32 v91, v82, 0x41500000, v83
    v_sin_f32 v92, v88
    v_cos_f32 v88, v88
    v_sin_f32 v93, v89
    v_cos_f32 v89, v89
    v_sin_f32 v94, v90
    v_cos_f32 v90, v90
    v_sin_f32 v95, v91
    v_cos_f32 v91, v91
    v_cvt_pk_bf16_f32 v88, v88, -v92
    v_cvt_pk_bf16_f32 v89, v89, -v93
    v_cvt_pk_bf16_f32 v90, v90, -v94
    v_cvt_pk_bf16_f32 v91, v91, -v95
    v_accvgpr_write_b32 a64, v88
    v_accvgpr_write_b32 a65, v89
    v_accvgpr_write_b32 a66, v90
    v_accvgpr_write_b32 a67, v91
    v_fmamk_f32 v88, v82, 0x40000000, v83
    v_fmamk_f32 v89, v82, 0x40c00000, v83
    v_fmamk_f32 v90, v82, 0x41200000, v83
    v_fmamk_f32 v91, v82, 0x41600000, v83
    v_sin_f32 v92, v88
    v_cos_f32 v88, v88
    v_sin_f32 v93, v89
    v_cos_f32 v89, v89
    v_sin_f32 v94, v90
    v_cos_f32 v90, v90
    v_sin_f32 v95, v91
    v_cos_f32 v91, v91
    v_cvt_pk_bf16_f32 v88, v88, -v92
    buffer_load_dword v10, v9, s[16:19], s63 offen sc1
    v_cvt_pk_bf16_f32 v89, v89, -v93
    v_cvt_pk_bf16_f32 v90, v90, -v94
    v_cvt_pk_bf16_f32 v91, v91, -v95
    v_accvgpr_write_b32 a80, v88
    v_accvgpr_write_b32 a81, v89
    v_accvgpr_write_b32 a82, v90
    v_accvgpr_write_b32 a83, v91
    v_fmamk_f32 v88, v82, 0x40400000, v83
    v_fmamk_f32 v89, v82, 0x40e00000, v83
    v_fmamk_f32 v90, v82, 0x41300000, v83
    v_fmamk_f32 v91, v82, 0x41700000, v83
    v_sin_f32 v92, v88
    v_cos_f32 v88, v88
    v_sin_f32 v93, v89
    v_cos_f32 v89, v89
    v_sin_f32 v94, v90
    v_cos_f32 v90, v90
    v_sin_f32 v95, v91
    v_cos_f32 v91, v91
    v_cvt_pk_bf16_f32 v88, v88, -v92
    v_cvt_pk_bf16_f32 v89, v89, -v93
    v_cvt_pk_bf16_f32 v90, v90, -v94
    v_cvt_pk_bf16_f32 v91, v91, -v95
    v_accvgpr_write_b32 a96, v88
    v_accvgpr_write_b32 a97, v89
    v_accvgpr_write_b32 a98, v90
    v_accvgpr_write_b32 a99, v91
    s_lshr_b32 s77, s72, 1
    s_mul_i32 s66, s77, 0x80008000
    s_mul_i32 s77, s72, 1
    s_and_b32 s77, s77, 3
    s_and_b32 s78, s77, 1
    s_lshl_b32 s68, s78, 4
    s_lshr_b32 s78, s77, 1
    s_xor_b32 s79, s77, s78
    s_lshl_b32 s79, s79, 31
    s_lshl_b32 s78, s78, 15
    s_or_b32 s52, s79, s78
    s_mul_i32 s77, s72, 2
    s_and_b32 s77, s77, 3
    s_and_b32 s78, s77, 1
    s_lshl_b32 s69, s78, 4
    s_lshr_b32 s78, s77, 1
    s_xor_b32 s79, s77, s78
    s_lshl_b32 s79, s79, 31
    s_lshl_b32 s78, s78, 15
    s_or_b32 s53, s79, s78
    s_mul_i32 s77, s72, 3
    s_and_b32 s77, s77, 3
    s_and_b32 s78, s77, 1
    s_lshl_b32 s70, s78, 4
    s_lshr_b32 s78, s77, 1
    s_xor_b32 s79, s77, s78
    s_lshl_b32 s79, s79, 31
    s_lshl_b32 s78, s78, 15
    s_or_b32 s54, s79, s78
    v_lshlrev_b32 v22, 4, v8
    v_lshl_add_u32 v22, v4, 10, v22
    s_lshl_b32 s77, s72, 2
    s_add_u32 s77, s77, 114688
    v_add_u32 v22, s77, v22
    v_add_u32 v23, 114688, v7
    s_mov_b32 s77, 114688
    v_lshlrev_b32 v21, 4, v3
    v_mad_u32_u24 v21, v2, s77, v21
    s_mul_i32 s58, s72, 28672
    s_mul_i32 s78, s44, 1792
    s_add_u32 s58, s58, s78
    s_lshl_b32 s78, s45, 7
    s_add_u32 s58, s58, s78
    s_add_u32 s58, s58, 2883584
    s_add_u32 s59, s58, 917504
    s_lshl_b32 s77, s72, 11
    s_add_u32 s77, s77, 151552
    v_xor_b32 v14, v4, v3
    v_lshlrev_b32 v14, 4, v14
    v_lshl_add_u32 v14, v8, 7, v14
    v_add_u32 v14, s77, v14
    v_xor_b32 v15, 64, v14
    v_xor_b32 v16, v2, v3
    v_lshlrev_b32 v16, 4, v16
    v_lshl_add_u32 v16, v2, 7, v16
    v_add_u32 v16, s77, v16
    v_lshlrev_b32 v17, 14, v1
    v_mov_b32 v18, s44
    v_cvt_f32_u32 v18, v18
    v_mul_f32 v18, 0x3d000000, v18
    v_sin_f32 v19, v18
    v_cos_f32 v18, v18
    s_cmp_lg_u32 s45, 0
    s_cbranch_scc1 L_sp8
    s_waitcnt vmcnt(17)
    v_subrev_u32 v130, s73, v130
    s_waitcnt vmcnt(17)
    v_subrev_u32 v134, s73, v134
    v_max_u32 v130, v130, v134
    v_cmp_le_u32 vcc, 1, v130
    s_nop 0
    s_cmp_eq_u64 vcc, 0
    s_cbranch_scc1 L_pd19
    s_mov_b32 s96, 300000
L_pl19:
    s_sleep 10
    buffer_load_dwordx4 v[128:131], v20, s[16:19], s65 offen offset:0 sc1
    buffer_load_dwordx4 v[132:135], v20, s[16:19], s65 offen offset:256 sc1
    s_waitcnt vmcnt(0)
    v_subrev_u32 v130, s73, v130
    v_subrev_u32 v134, s73, v134
    v_max_u32 v130, v130, v134
    v_cmp_le_u32 vcc, 1, v130
    s_sub_u32 s96, s96, 1
    s_cmp_eq_u32 s96, 0
    s_cbranch_scc1 L_pd19
    s_cmp_eq_u64 vcc, 0
    s_cbranch_scc0 L_pl19
L_pd19:
    v_cmp_ne_u32 vcc, 0, v8
    v_lshlrev_b32 v136, 16, v128
    v_and_b32 v137, 0xffff0000, v128
    v_lshlrev_b32 v138, 16, v129
    v_and_b32 v139, 0xffff0000, v129
    v_lshlrev_b32 v140, 16, v132
    v_and_b32 v141, 0xffff0000, v132
    v_lshlrev_b32 v142, 16, v133
    v_and_b32 v143, 0xffff0000, v133
    s_waitcnt vmcnt(16)
    v_cndmask_b32_dpp v96, v136, v96, vcc quad_perm:[0,1,2,3] row_mask:0xf bank_mask:0xf bound_ctrl:0
    v_mov_b32_dpp v112, v138 quad_perm:[0,1,2,3] row_mask:0xf bank_mask:0xf bound_ctrl:0
    s_waitcnt vmcnt(15)
    v_cndmask_b32_dpp v104, v137, v104, vcc quad_perm:[0,1,2,3] row_mask:0xf bank_mask:0xf bound_ctrl:0
    v_mov_b32_dpp v120, v139 quad_perm:[0,1,2,3] row_mask:0xf bank_mask:0xf bound_ctrl:0
    s_waitcnt vmcnt(14)
    v_cndmask_b32_dpp v97, v136, v97, vcc row_shl:4 row_mask:0xf bank_mask:0xf bound_ctrl:0
    v_mov_b32_dpp v113, v138 row_shl:4 row_mask:0xf bank_mask:0xf bound_ctrl:0
    s_waitcnt vmcnt(13)
    v_cndmask_b32_dpp v105, v137, v105, vcc row_shl:4 row_mask:0xf bank_mask:0xf bound_ctrl:0
    v_mov_b32_dpp v121, v139 row_shl:4 row_mask:0xf bank_mask:0xf bound_ctrl:0
    s_waitcnt vmcnt(12)
    v_cndmask_b32_dpp v98, v136, v98, vcc row_shl:8 row_mask:0xf bank_mask:0xf bound_ctrl:0
    v_mov_b32_dpp v114, v138 row_shl:8 row_mask:0xf bank_mask:0xf bound_ctrl:0
    s_waitcnt vmcnt(11)
    v_cndmask_b32_dpp v106, v137, v106, vcc row_shl:8 row_mask:0xf bank_mask:0xf bound_ctrl:0
    v_mov_b32_dpp v122, v139 row_shl:8 row_mask:0xf bank_mask:0xf bound_ctrl:0
    s_waitcnt vmcnt(10)
    v_cndmask_b32_dpp v99, v136, v99, vcc row_shl:12 row_mask:0xf bank_mask:0xf bound_ctrl:0
    v_mov_b32_dpp v115, v138 row_shl:12 row_mask:0xf bank_mask:0xf bound_ctrl:0
    s_waitcnt vmcnt(9)
    v_cndmask_b32_dpp v107, v137, v107, vcc row_shl:12 row_mask:0xf bank_mask:0xf bound_ctrl:0
    v_mov_b32_dpp v123, v139 row_shl:12 row_mask:0xf bank_mask:0xf bound_ctrl:0
    s_waitcnt vmcnt(8)
    v_cndmask_b32_dpp v100, v140, v100, vcc quad_perm:[0,1,2,3] row_mask:0xf bank_mask:0xf bound_ctrl:0
    v_mov_b32_dpp v116, v142 quad_perm:[0,1,2,3] row_mask:0xf bank_mask:0xf bound_ctrl:0
    s_waitcnt vmcnt(7)
    v_cndmask_b32_dpp v108, v141, v108, vcc quad_perm:[0,1,2,3] row_mask:0xf bank_mask:0xf bound_ctrl:0
    v_mov_b32_dpp v124, v143 quad_perm:[0,1,2,3] row_mask:0xf bank_mask:0xf bound_ctrl:0
    s_waitcnt vmcnt(6)
    v_cndmask_b32_dpp v101, v140, v101, vcc row_shl:4 row_mask:0xf bank_mask:0xf bound_ctrl:0
    v_mov_b32_dpp v117, v142 row_shl:4 row_mask:0xf bank_mask:0xf bound_ctrl:0
    s_waitcnt vmcnt(5)
    v_cndmask_b32_dpp v109, v141, v109, vcc row_shl:4 row_mask:0xf bank_mask:0xf bound_ctrl:0
    v_mov_b32_dpp v125, v143 row_shl:4 row_mask:0xf bank_mask:0xf bound_ctrl:0
    s_waitcnt vmcnt(4)
    v_cndmask_b32_dpp v102, v140, v102, vcc row_shl:8 row_mask:0xf bank_mask:0xf bound_ctrl:0
    v_mov_b32_dpp v118, v142 row_shl:8 row_mask:0xf bank_mask:0xf bound_ctrl:0
    s_waitcnt vmcnt(3)
    v_cndmask_b32_dpp v110, v141, v110, vcc row_shl:8 row_mask:0xf bank_mask:0xf bound_ctrl:0
    v_mov_b32_dpp v126, v143 row_shl:8 row_mask:0xf bank_mask:0xf bound_ctrl:0
    s_waitcnt vmcnt(2)
    v_cndmask_b32_dpp v103, v140, v103, vcc row_shl:12 row_mask:0xf bank_mask:0xf bound_ctrl:0
    v_mov_b32_dpp v119, v142 row_shl:12 row_mask:0xf bank_mask:0xf bound_ctrl:0
    s_waitcnt vmcnt(1)
    v_cndmask_b32_dpp v111, v141, v111, vcc row_shl:12 row_mask:0xf bank_mask:0xf bound_ctrl:0
    v_mov_b32_dpp v127, v143 row_shl:12 row_mask:0xf bank_mask:0xf bound_ctrl:0
L_sp8:
    s_setprio 2
    s_waitcnt vmcnt(0)
    v_subrev_u32 v10, s73, v10
    v_cmp_le_u32 vcc, 1, v10
    s_nop 0
    s_cmp_eq_u64 vcc, 0
    s_cbranch_scc1 L_pd18
    s_mov_b32 s96, 300000
L_pl18:
    s_sleep 10
    buffer_load_dword v10, v9, s[16:19], s63 offen sc1
    s_waitcnt vmcnt(0)
    v_subrev_u32 v10, s73, v10
    v_cmp_le_u32 vcc, 1, v10
    s_sub_u32 s96, s96, 1
    s_cmp_eq_u32 s96, 0
    s_cbranch_scc1 L_pd18
    s_cmp_eq_u64 vcc, 0
    s_cbranch_scc0 L_pl18
L_pd18:
    s_and_b32 s78, s72, 1
    s_lshl_b32 s78, s78, 4
    s_add_u32 s78, s78, s44
    s_lshl_b32 s77, s78, 12
    s_add_u32 s77, s77, s55
    buffer_load_dwordx4 v[32:35], v7, s[16:19], s77 offen offset:0 sc1
    buffer_load_dwordx4 v[36:39], v7, s[16:19], s77 offen offset:1024 sc1
    buffer_load_dwordx4 v[40:43], v7, s[16:19], s77 offen offset:2048 sc1
    buffer_load_dwordx4 v[44:47], v7, s[16:19], s77 offen offset:3072 sc1
    s_lshl_b32 s61, s44, 1
    s_add_u32 s61, s61, s46
    s_lshl_b32 s61, s61, 9
    s_add_u32 s61, s61, 32768
    v_lshlrev_b32 v11, 3, v1
    buffer_load_dwordx2 v[12:13], v11, s[16:19], s61 offen sc1
    s_cmp_lg_u32 s45, 0
    s_cbranch_scc1 L_sp5
    v_lshlrev_b32 v64, 26, v8
    v_lshl_add_u32 v64, v4, 7, v64
    s_lshl_b32 s77, s78, 11
    s_add_u32 s77, s77, 327680
    buffer_load_dwordx4 v[48:51], v64, s[16:19], s77 offen offset:0 sc1
    buffer_load_dwordx4 v[52:55], v64, s[16:19], s77 offen offset:512 sc1
    buffer_load_dwordx4 v[56:59], v64, s[16:19], s77 offen offset:1024 sc1
    buffer_load_dwordx4 v[60:63], v64, s[16:19], s77 offen offset:1536 sc1
L_sp5:
    ds_read_b128 v[28:31], v27 offset:16
    s_waitcnt lgkmcnt(0)
    v_min_u32 v28, v28, v29
    v_min3_u32 v28, v28, v30, v31
    v_cmp_gt_u32 vcc, 9, v28
    s_nop 0
    s_cmp_eq_u64 vcc, 0
    s_cbranch_scc1 L_pd20
    s_mov_b32 s96, 300000
L_pl20:
    s_sleep 1
    ds_read_b128 v[28:31], v27 offset:16
    s_waitcnt lgkmcnt(0)
    v_min_u32 v28, v28, v29
    v_min3_u32 v28, v28, v30, v31
    v_cmp_gt_u32 vcc, 9, v28
    s_sub_u32 s96, s96, 1
    s_cmp_eq_u32 s96, 0
    s_cbranch_scc1 L_pd20
    s_cmp_eq_u64 vcc, 0
    s_cbranch_scc0 L_pl20
L_pd20:
    s_waitcnt vmcnt(4)
    v_mfma_f32_16x16x32_bf16 v[64:67], a[0:3], v[32:35], 0
    v_mfma_f32_16x16x32_bf16 v[68:71], a[16:19], v[32:35], 0
    v_mfma_f32_16x16x32_bf16 v[72:75], a[8:11], v[32:35], 0
    v_mfma_f32_16x16x32_bf16 v[76:79], a[24:27], v[32:35], 0
    s_waitcnt vmcnt(3)
    v_mfma_f32_16x16x32_bf16 v[64:67], a[4:7], v[36:39], v[64:67]
    v_mfma_f32_16x16x32_bf16 v[68:71], a[20:23], v[36:39], v[68:71]
    v_mfma_f32_16x16x32_bf16 v[72:75], a[12:15], v[36:39], v[72:75]
    v_mfma_f32_16x16x32_bf16 v[76:79], a[28:31], v[36:39], v[76:79]
    s_waitcnt vmcnt(2)
    v_xor_b32 v40, s66, v40
    v_xor_b32 v41, s66, v41
    v_xor_b32 v42, s66, v42
    v_xor_b32 v43, s66, v43
    s_nop 1
    v_mfma_f32_16x16x32_bf16 v[64:67], a[0:3], v[40:43], v[64:67]
    v_mfma_f32_16x16x32_bf16 v[68:71], a[16:19], v[40:43], v[68:71]
    v_mfma_f32_16x16x32_bf16 v[72:75], a[8:11], v[40:43], v[72:75]
    v_mfma_f32_16x16x32_bf16 v[76:79], a[24:27], v[40:43], v[76:79]
    s_waitcnt vmcnt(1)
    v_xor_b32 v44, s66, v44
    v_xor_b32 v45, s66, v45
    v_xor_b32 v46, s66, v46
    v_xor_b32 v47, s66, v47
    s_nop 1
    v_mfma_f32_16x16x32_bf16 v[64:67], a[4:7], v[44:47], v[64:67]
    v_mfma_f32_16x16x32_bf16 v[68:71], a[20:23], v[44:47], v[68:71]
    v_mfma_f32_16x16x32_bf16 v[72:75], a[12:15], v[44:47], v[72:75]
    v_mfma_f32_16x16x32_bf16 v[76:79], a[28:31], v[44:47], v[76:79]
    s_cmp_lg_u32 s45, 0
    s_cbranch_scc1 L_sp6
    s_waitcnt vmcnt(0)
    v_mfma_f32_16x16x32_bf16 v[80:83], a[0:3], v[48:51], 0
    v_mfma_f32_16x16x32_bf16 v[84:87], a[16:19], v[48:51], 0
    v_mfma_f32_16x16x32_bf16 v[88:91], a[8:11], v[48:51], 0
    v_mfma_f32_16x16x32_bf16 v[92:95], a[24:27], v[48:51], 0
    s_waitcnt vmcnt(0)
    v_mfma_f32_16x16x32_bf16 v[80:83], a[4:7], v[52:55], v[80:83]
    v_mfma_f32_16x16x32_bf16 v[84:87], a[20:23], v[52:55], v[84:87]
    v_mfma_f32_16x16x32_bf16 v[88:91], a[12:15], v[52:55], v[88:91]
    v_mfma_f32_16x16x32_bf16 v[92:95], a[28:31], v[52:55], v[92:95]
    s_waitcnt vmcnt(0)
    v_xor_b32 v56, s66, v56
    v_xor_b32 v57, s66, v57
    v_xor_b32 v58, s66, v58
    v_xor_b32 v59, s66, v59
    s_nop 1
    v_mfma_f32_16x16x32_bf16 v[80:83], a[0:3], v[56:59], v[80:83]
    v_mfma_f32_16x16x32_bf16 v[84:87], a[16:19], v[56:59], v[84:87]
    v_mfma_f32_16x16x32_bf16 v[88:91], a[8:11], v[56:59], v[88:91]
    v_mfma_f32_16x16x32_bf16 v[92:95], a[24:27], v[56:59], v[92:95]
    s_waitcnt vmcnt(0)
    v_xor_b32 v60, s66, v60
    v_xor_b32 v61, s66, v61
    v_xor_b32 v62, s66, v62
    v_xor_b32 v63, s66, v63
    s_nop 1
    v_mfma_f32_16x16x32_bf16 v[80:83], a[4:7], v[60:63], v[80:83]
    v_mfma_f32_16x16x32_bf16 v[84:87], a[20:23], v[60:63], v[84:87]
    v_mfma_f32_16x16x32_bf16 v[88:91], a[12:15], v[60:63], v[88:91]
    v_mfma_f32_16x16x32_bf16 v[92:95], a[28:31], v[60:63], v[92:95]
L_sp6:
    s_nop 2
    v_mul_f32 v128, v64, v96
    v_mul_f32 v136, v64, v104
    v_mul_f32 v129, v65, v97
    v_mul_f32 v137, v65, v105
    v_mul_f32 v130, v66, v98
    v_mul_f32 v138, v66, v106
    v_mul_f32 v131, v67, v99
    v_mul_f32 v139, v67, v107
    v_mul_f32 v132, v72, v100
    v_mul_f32 v140, v72, v108
    v_mul_f32 v133, v73, v101
    v_mul_f32 v141, v73, v109
    v_mul_f32 v134, v74, v102
    v_mul_f32 v142, v74, v110
    v_mul_f32 v135, v75, v103
    v_mul_f32 v143, v75, v111
    v_fma_f32 v128, -v68, v104, v128
    v_fmac_f32 v136, v68, v96
    v_fma_f32 v129, -v69, v105, v129
    v_fmac_f32 v137, v69, v97
    v_fma_f32 v130, -v70, v106, v130
    v_fmac_f32 v138, v70, v98
    v_fma_f32 v131, -v71, v107, v131
    v_fmac_f32 v139, v71, v99
    v_fma_f32 v132, -v76, v108, v132
    v_fmac_f32 v140, v76, v100
    v_fma_f32 v133, -v77, v109, v133
    v_fmac_f32 v141, v77, v101
    v_fma_f32 v134, -v78, v110, v134
    v_fmac_f32 v142, v78, v102
    v_fma_f32 v135, -v79, v111, v135
    v_fmac_f32 v143, v79, v103
    s_cmp_lg_u32 s45, 0
    s_cbranch_scc1 L_sp7
    v_fma_f32 v128, -v80, v120, v128
    v_fmac_f32 v136, v80, v112
    v_fma_f32 v129, -v81, v121, v129
    v_fmac_f32 v137, v81, v113
    v_fma_f32 v130, -v82, v122, v130
    v_fmac_f32 v138, v82, v114
    v_fma_f32 v131, -v83, v123, v131
    v_fmac_f32 v139, v83, v115
    v_fma_f32 v132, -v88, v124, v132
    v_fmac_f32 v140, v88, v116
    v_fma_f32 v133, -v89, v125, v133
    v_fmac_f32 v141, v89, v117
    v_fma_f32 v134, -v90, v126, v134
    v_fmac_f32 v142, v90, v118
    v_fma_f32 v135, -v91, v127, v135
    v_fmac_f32 v143, v91, v119
    v_fma_f32 v128, -v84, v112, v128
    v_fma_f32 v136, -v84, v120, v136
    v_fma_f32 v129, -v85, v113, v129
    v_fma_f32 v137, -v85, v121, v137
    v_fma_f32 v130, -v86, v114, v130
    v_fma_f32 v138, -v86, v122, v138
    v_fma_f32 v131, -v87, v115, v131
    v_fma_f32 v139, -v87, v123, v139
    v_fma_f32 v132, -v92, v116, v132
    v_fma_f32 v140, -v92, v124, v140
    v_fma_f32 v133, -v93, v117, v133
    v_fma_f32 v141, -v93, v125, v141
    v_fma_f32 v134, -v94, v118, v134
    v_fma_f32 v142, -v94, v126, v142
    v_fma_f32 v135, -v95, v119, v135
    v_fma_f32 v143, -v95, v127, v143
L_sp7:
    v_cvt_pk_bf16_f32 v128, v128, -v136
    v_cvt_pk_bf16_f32 v129, v129, -v137
    v_cvt_pk_bf16_f32 v130, v130, -v138
    v_cvt_pk_bf16_f32 v131, v131, -v139
    v_cvt_pk_bf16_f32 v132, v132, -v140
    v_cvt_pk_bf16_f32 v133, v133, -v141
    v_cvt_pk_bf16_f32 v134, v134, -v142
    v_cvt_pk_bf16_f32 v135, v135, -v143
    ds_write_b32 v22, v128 offset:0
    ds_write_b32 v22, v129 offset:256
    ds_write_b32 v22, v130 offset:512
    ds_write_b32 v22, v131 offset:768
    ds_write_b32 v22, v132 offset:4096
    ds_write_b32 v22, v133 offset:4352
    ds_write_b32 v22, v134 offset:4608
    ds_write_b32 v22, v135 offset:4864
    v_mov_b32 v28, 10
    ds_write_b32 v26, v28 offset:16
    ds_read_b128 v[28:31], v27 offset:16
    s_waitcnt lgkmcnt(0)
    v_min_u32 v28, v28, v29
    v_min3_u32 v28, v28, v30, v31
    v_cmp_gt_u32 vcc, 10, v28
    s_nop 0
    s_cmp_eq_u64 vcc, 0
    s_cbranch_scc1 L_pd21
    s_mov_b32 s96, 300000
L_pl21:
    s_sleep 1
    ds_read_b128 v[28:31], v27 offset:16
    s_waitcnt lgkmcnt(0)
    v_min_u32 v28, v28, v29
    v_min3_u32 v28, v28, v30, v31
    v_cmp_gt_u32 vcc, 10, v28
    s_sub_u32 s96, s96, 1
    s_cmp_eq_u32 s96, 0
    s_cbranch_scc1 L_pd21
    s_cmp_eq_u64 vcc, 0
    s_cbranch_scc0 L_pl21
L_pd21:
    ds_read_b128 v[32:35], v23 offset:0
    ds_read_b128 v[36:39], v23 offset:1024
    ds_read_b128 v[40:43], v23 offset:2048
    ds_read_b128 v[44:47], v23 offset:3072
    s_waitcnt vmcnt(0)
    ds_read_b128 v[48:51], v23 offset:4096
    s_waitcnt vmcnt(0)
    ds_read_b128 v[52:55], v23 offset:5120
    ds_read_b128 v[56:59], v23 offset:6144
    ds_read_b128 v[60:63], v23 offset:7168
    s_waitcnt lgkmcnt(7)
    v_mfma_f32_16x16x32_bf16 v[64:67], v[32:35], a[0:3], 0
    v_mfma_f32_16x16x32_bf16 v[68:71], v[32:35], a[16:19], 0
    v_mfma_f32_16x16x32_bf16 v[72:75], v[32:35], a[8:11], 0
    v_mfma_f32_16x16x32_bf16 v[76:79], v[32:35], a[24:27], 0
    s_waitcnt lgkmcnt(6)
    v_mfma_f32_16x16x32_bf16 v[64:67], v[36:39], a[4:7], v[64:67]
    v_mfma_f32_16x16x32_bf16 v[68:71], v[36:39], a[20:23], v[68:71]
    v_mfma_f32_16x16x32_bf16 v[72:75], v[36:39], a[12:15], v[72:75]
    v_mfma_f32_16x16x32_bf16 v[76:79], v[36:39], a[28:31], v[76:79]
    s_waitcnt lgkmcnt(5)
    v_alignbit_b32 v40, v40, v40, s68
    v_alignbit_b32 v41, v41, v41, s68
    v_alignbit_b32 v42, v42, v42, s68
    v_alignbit_b32 v43, v43, v43, s68
    v_xor_b32 v40, s52, v40
    v_xor_b32 v41, s52, v41
    v_xor_b32 v42, s52, v42
    v_xor_b32 v43, s52, v43
    s_nop 1
    v_mfma_f32_16x16x32_bf16 v[64:67], v[40:43], a[0:3], v[64:67]
    v_mfma_f32_16x16x32_bf16 v[68:71], v[40:43], a[16:19], v[68:71]
    v_mfma_f32_16x16x32_bf16 v[72:75], v[40:43], a[8:11], v[72:75]
    v_mfma_f32_16x16x32_bf16 v[76:79], v[40:43], a[24:27], v[76:79]
    s_waitcnt lgkmcnt(4)
    v_alignbit_b32 v44, v44, v44, s68
    v_alignbit_b32 v45, v45, v45, s68
    v_alignbit_b32 v46, v46, v46, s68
    v_alignbit_b32 v47, v47, v47, s68
    v_xor_b32 v44, s52, v44
    v_xor_b32 v45, s52, v45
    v_xor_b32 v46, s52, v46
    v_xor_b32 v47, s52, v47
    s_nop 1
    v_mfma_f32_16x16x32_bf16 v[64:67], v[44:47], a[4:7], v[64:67]
    v_mfma_f32_16x16x32_bf16 v[68:71], v[44:47], a[20:23], v[68:71]
    v_mfma_f32_16x16x32_bf16 v[72:75], v[44:47], a[12:15], v[72:75]
    v_mfma_f32_16x16x32_bf16 v[76:79], v[44:47], a[28:31], v[76:79]
    s_waitcnt lgkmcnt(3)
    v_xor_b32 v48, s53, v48
    v_xor_b32 v49, s53, v49
    v_xor_b32 v50, s53, v50
    v_xor_b32 v51, s53, v51
    s_nop 1
    v_mfma_f32_16x16x32_bf16 v[64:67], v[48:51], a[0:3], v[64:67]
    v_mfma_f32_16x16x32_bf16 v[68:71], v[48:51], a[16:19], v[68:71]
    v_mfma_f32_16x16x32_bf16 v[72:75], v[48:51], a[8:11], v[72:75]
    v_mfma_f32_16x16x32_bf16 v[76:79], v[48:51], a[24:27], v[76:79]
    s_waitcnt lgkmcnt(2)
    v_xor_b32 v52, s53, v52
    v_xor_b32 v53, s53, v53
    v_xor_b32 v54, s53, v54
    v_xor_b32 v55, s53, v55
    s_nop 1
    v_mfma_f32_16x16x32_bf16 v[64:67], v[52:55], a[4:7], v[64:67]
    v_mfma_f32_16x16x32_bf16 v[68:71], v[52:55], a[20:23], v[68:71]
    v_mfma_f32_16x16x32_bf16 v[72:75], v[52:55], a[12:15], v[72:75]
    v_mfma_f32_16x16x32_bf16 v[76:79], v[52:55], a[28:31], v[76:79]
    s_waitcnt lgkmcnt(1)
    v_alignbit_b32 v56, v56, v56, s70
    v_alignbit_b32 v57, v57, v57, s70
    v_alignbit_b32 v58, v58, v58, s70
    v_alignbit_b32 v59, v59, v59, s70
    v_xor_b32 v56, s54, v56
    v_xor_b32 v57, s54, v57
    v_xor_b32 v58, s54, v58
    v_xor_b32 v59, s54, v59
    s_nop 1
    v_mfma_f32_16x16x32_bf16 v[64:67], v[56:59], a[0:3], v[64:67]
    v_mfma_f32_16x16x32_bf16 v[68:71], v[56:59], a[16:19], v[68:71]
    v_mfma_f32_16x16x32_bf16 v[72:75], v[56:59], a[8:11], v[72:75]
    v_mfma_f32_16x16x32_bf16 v[76:79], v[56:59], a[24:27], v[76:79]
    s_waitcnt lgkmcnt(0)
    v_alignbit_b32 v60, v60, v60, s70
    v_alignbit_b32 v61, v61, v61, s70
    v_alignbit_b32 v62, v62, v62, s70
    v_alignbit_b32 v63, v63, v63, s70
    v_xor_b32 v60, s54, v60
    v_xor_b32 v61, s54, v61
    v_xor_b32 v62, s54, v62
    v_xor_b32 v63, s54, v63
    s_nop 1
    v_mfma_f32_16x16x32_bf16 v[64:67], v[60:63], a[4:7], v[64:67]
    v_mfma_f32_16x16x32_bf16 v[68:71], v[60:63], a[20:23], v[68:71]
    v_mfma_f32_16x16x32_bf16 v[72:75], v[60:63], a[12:15], v[72:75]
    v_mfma_f32_16x16x32_bf16 v[76:79], v[60:63], a[28:31], v[76:79]
    s_nop 5
    v_cvt_pk_bf16_f32 v128, v64, -v68
    v_cvt_pk_bf16_f32 v129, v65, -v69
    v_cvt_pk_bf16_f32 v130, v66, -v70
    v_cvt_pk_bf16_f32 v131, v67, -v71
    ds_write_b128 v14, v[128:131]
    v_mul_f32 v80, v19, v76
    v_mul_f32 v84, v19, v72
    v_mul_f32 v81, v19, v77
    v_mul_f32 v85, v19, v73
    v_mul_f32 v82, v19, v78
    v_mul_f32 v86, v19, v74
    v_mul_f32 v83, v19, v79
    v_mul_f32 v87, v19, v75
    v_fma_f32 v72, v18, v72, v80
    v_fma_f32 v76, v18, v76, -v84
    v_fma_f32 v73, v18, v73, v81
    v_fma_f32 v77, v18, v77, -v85
    v_fma_f32 v74, v18, v74, v82
    v_fma_f32 v78, v18, v78, -v86
    v_fma_f32 v75, v18, v75, v83
    v_fma_f32 v79, v18, v79, -v87
    v_cvt_pk_bf16_f32 v132, v72, -v76
    v_cvt_pk_bf16_f32 v133, v73, -v77
    v_cvt_pk_bf16_f32 v134, v74, -v78
    v_cvt_pk_bf16_f32 v135, v75, -v79
    ds_write_b128 v15, v[132:135]
    ds_read_b128 v[136:139], v16 offset:0
    ds_read_b128 v[140:143], v16 offset:1024
    ds_read_b128 v[28:31], v27 offset:0
    s_waitcnt lgkmcnt(2)
    buffer_store_dwordx4 v[136:139], v21, s[16:19], s58 offen sc1
    s_waitcnt lgkmcnt(1)
    buffer_store_dwordx4 v[140:143], v21, s[16:19], s59 offen sc1
    s_waitcnt lgkmcnt(0)
    v_min_u32 v28, v28, v29
    v_min3_u32 v28, v28, v30, v31
    v_cmp_gt_u32 vcc, 1, v28
    s_nop 0
    s_cmp_eq_u64 vcc, 0
    s_cbranch_scc1 L_pd22
    s_mov_b32 s96, 300000
L_pl22:
    s_sleep 1
    ds_read_b128 v[28:31], v27 offset:0
    s_waitcnt lgkmcnt(0)
    v_min_u32 v28, v28, v29
    v_min3_u32 v28, v28, v30, v31
    v_cmp_gt_u32 vcc, 1, v28
    s_sub_u32 s96, s96, 1
    s_cmp_eq_u32 s96, 0
    s_cbranch_scc1 L_pd22
    s_cmp_eq_u64 vcc, 0
    s_cbranch_scc0 L_pl22
L_pd22:
    v_subrev_u32 v13, s73, v13
    v_cmp_le_u32 vcc, 1, v13
    s_nop 0
    s_cmp_eq_u64 vcc, 0
    s_cbranch_scc1 L_pd23
    s_mov_b32 s96, 300000
L_pl23:
    s_sleep 10
    buffer_load_dwordx2 v[12:13], v11, s[16:19], s61 offen sc1
    s_waitcnt vmcnt(0)
    v_subrev_u32 v13, s73, v13
    v_cmp_le_u32 vcc, 1, v13
    s_sub_u32 s96, s96, 1
    s_cmp_eq_u32 s96, 0
    s_cbranch_scc1 L_pd23
    s_cmp_eq_u64 vcc, 0
    s_cbranch_scc0 L_pl23
L_pd23:
    v_lshlrev_b32 v11, 2, v1
    v_add_u32 v11, 161792, v11
    ds_write_b32 v11, v12
    s_lshl_b32 s77, s46, 1
    s_lshl_b32 s64, s44, 2
    s_add_u32 s64, s64, s77
    s_setprio 0
    v_lshlrev_b32 v33, 2, v4
    v_cvt_f32_u32 v33, v33
    s_lshr_b32 s77, s72, 1
    s_add_u32 s53, s64, s77
    s_xor_b32 s52, s53, 1
    s_lshl_b32 s77, s72, 6
    s_add_u32 s77, s77, 161792
    v_lshl_add_u32 v34, v8, 2, s77
    ds_read_b32 v25, v34
    v_lshl_add_u32 v34, v8, 7, s52
    v_cvt_f32_u32 v34, v34
    v_mul_f32 v34, 0x3a000000, v34
    v_mul_f32 v35, v34, v33
    v_fmamk_f32 v40, v34, 0x00000000, v35
    v_fmamk_f32 v41, v34, 0x3f800000, v35
    v_fmamk_f32 v42, v34, 0x40000000, v35
    v_fmamk_f32 v43, v34, 0x40400000, v35
    v_sin_f32 v44, v40
    v_cos_f32 v40, v40
    v_sin_f32 v45, v41
    v_cos_f32 v41, v41
    v_sin_f32 v46, v42
    v_cos_f32 v42, v42
    v_sin_f32 v47, v43
    v_cos_f32 v43, v43
    v_cvt_pk_bf16_f32 v96, v40, -v44
    v_cvt_pk_bf16_f32 v100, v44, v40
    v_cvt_pk_bf16_f32 v97, v41, -v45
    v_cvt_pk_bf16_f32 v101, v45, v41
    v_cvt_pk_bf16_f32 v98, v42, -v46
    v_cvt_pk_bf16_f32 v102, v46, v42
    v_cvt_pk_bf16_f32 v99, v43, -v47
    v_cvt_pk_bf16_f32 v103, v47, v43
    v_lshl_add_u32 v34, v8, 7, s53
    v_cvt_f32_u32 v34, v34
    v_mul_f32 v34, 0x3a000000, v34
    v_mul_f32 v35, v34, v33
    v_fmamk_f32 v40, v34, 0x00000000, v35
    v_fmamk_f32 v41, v34, 0x3f800000, v35
    v_fmamk_f32 v42, v34, 0x40000000, v35
    v_fmamk_f32 v43, v34, 0x40400000, v35
    v_sin_f32 v44, v40
    v_cos_f32 v40, v40
    v_sin_f32 v45, v41
    v_cos_f32 v41, v41
    v_sin_f32 v46, v42
    v_cos_f32 v42, v42
    v_sin_f32 v47, v43
    v_cos_f32 v43, v43
    v_cvt_pk_bf16_f32 v104, v40, -v44
    v_cvt_pk_bf16_f32 v108, v44, v40
    v_cvt_pk_bf16_f32 v105, v41, -v45
    v_cvt_pk_bf16_f32 v109, v45, v41
    v_cvt_pk_bf16_f32 v106, v42, -v46
    v_cvt_pk_bf16_f32 v110, v46, v42
    v_cvt_pk_bf16_f32 v107, v43, -v47
    v_cvt_pk_bf16_f32 v111, v47, v43
    s_waitcnt lgkmcnt(0)
    v_sub_f32 v11, 1.0, v25
    v_mul_f32 v25, 0x36124925, v25
    s_lshl_b32 s68, s47, 6
    v_add_u32 v80, s68, v8
    v_cvt_f32_u32 v80, v80
    s_lshl_b32 s68, s72, 6
    v_bfe_u32 v81, v1, 4, 1
    v_lshl_add_u32 v81, v81, 1, v5
    v_lshl_add_u32 v81, v81, 4, s68
    v_cvt_f32_u32 v81, v81
    v_and_b32 v84, 1, v1
    v_lshlrev_b32 v84, 31, v84
    v_or_b32 v84, 0x3e803e80, v84
    s_waitcnt vmcnt(0)
    s_mov_b64 exec, 15
    buffer_store_dword v24, v17, s[16:19], s62 offen sc1
    s_mov_b64 exec, -1
    s_setprio 0
    v_cmp_eq_u32 s[70:71], 0, v81
    v_add_f32 v82, 0x41800000, v80
    v_mul_f32 v82, 0x3b124925, v82
    v_mul_f32 v83, v82, v81
    v_fract_f32 v83, v83
    v_fmamk_f32 v88, v82, 0x00000000, v83
    v_fmamk_f32 v89, v82, 0x40800000, v83
    v_fmamk_f32 v90, v82, 0x41000000, v83
    v_fmamk_f32 v91, v82, 0x41400000, v83
    v_sin_f32 v92, v88
    v_cos_f32 v88, v88
    v_sin_f32 v93, v89
    v_cos_f32 v89, v89
    v_sin_f32 v94, v90
    v_cos_f32 v90, v90
    v_sin_f32 v95, v91
    v_cos_f32 v91, v91
    v_cvt_pk_bf16_f32 v88, v88, -v92
    v_cvt_pk_bf16_f32 v89, v89, -v93
    v_cvt_pk_bf16_f32 v90, v90, -v94
    v_cvt_pk_bf16_f32 v91, v91, -v95
    v_cndmask_b32 v88, v88, v84, s[70:71]
    v_accvgpr_write_b32 a52, v88
    v_accvgpr_write_b32 a53, v89
    v_accvgpr_write_b32 a54, v90
    v_accvgpr_write_b32 a55, v91
    v_fmamk_f32 v88, v82, 0x3f800000, v83
    v_fmamk_f32 v89, v82, 0x40a00000, v83
    v_fmamk_f32 v90, v82, 0x41100000, v83
    v_fmamk_f32 v91, v82, 0x41500000, v83
    v_sin_f32 v92, v88
    v_cos_f32 v88, v88
    v_sin_f32 v93, v89
    v_cos_f32 v89, v89
    v_sin_f32 v94, v90
    v_cos_f32 v90, v90
    v_sin_f32 v95, v91
    v_cos_f32 v91, v91
    v_cvt_pk_bf16_f32 v88, v88, -v92
    v_cvt_pk_bf16_f32 v89, v89, -v93
    v_cvt_pk_bf16_f32 v90, v90, -v94
    v_cvt_pk_bf16_f32 v91, v91, -v95
    v_accvgpr_write_b32 a68, v88
    v_accvgpr_write_b32 a69, v89
    v_accvgpr_write_b32 a70, v90
    v_accvgpr_write_b32 a71, v91
    v_fmamk_f32 v88, v82, 0x40000000, v83
    v_fmamk_f32 v89, v82, 0x40c00000, v83
    v_fmamk_f32 v90, v82, 0x41200000, v83
    v_fmamk_f32 v91, v82, 0x41600000, v83
    v_sin_f32 v92, v88
    v_cos_f32 v88, v88
    v_sin_f32 v93, v89
    v_cos_f32 v89, v89
    v_sin_f32 v94, v90
    v_cos_f32 v90, v90
    v_sin_f32 v95, v91
    v_cos_f32 v91, v91
    v_cvt_pk_bf16_f32 v88, v88, -v92
    v_cvt_pk_bf16_f32 v89, v89, -v93
    v_cvt_pk_bf16_f32 v90, v90, -v94
    v_cvt_pk_bf16_f32 v91, v91, -v95
    v_accvgpr_write_b32 a84, v88
    v_accvgpr_write_b32 a85, v89
    v_accvgpr_write_b32 a86, v90
    v_accvgpr_write_b32 a87, v91
    v_fmamk_f32 v88, v82, 0x40400000, v83
    v_fmamk_f32 v89, v82, 0x40e00000, v83
    v_fmamk_f32 v90, v82, 0x41300000, v83
    v_fmamk_f32 v91, v82, 0x41700000, v83
    v_sin_f32 v92, v88
    v_cos_f32 v88, v88
    v_sin_f32 v93, v89
    v_cos_f32 v89, v89
    v_sin_f32 v94, v90
    v_cos_f32 v90, v90
    v_sin_f32 v95, v91
    v_cos_f32 v91, v91
    v_cvt_pk_bf16_f32 v88, v88, -v92
    v_cvt_pk_bf16_f32 v89, v89, -v93
    v_cvt_pk_bf16_f32 v90, v90, -v94
    v_cvt_pk_bf16_f32 v91, v91, -v95
    v_accvgpr_write_b32 a100, v88
    v_accvgpr_write_b32 a101, v89
    v_accvgpr_write_b32 a102, v90
    v_accvgpr_write_b32 a103, v91
    v_add_f32 v82, 0x42000000, v80
    v_mul_f32 v82, 0x3b124925, v82
    v_mul_f32 v83, v82, v81
    v_fract_f32 v83, v83
    v_fmamk_f32 v88, v82, 0x00000000, v83
    v_fmamk_f32 v89, v82, 0x40800000, v83
    v_fmamk_f32 v90, v82, 0x41000000, v83
    v_fmamk_f32 v91, v82, 0x41400000, v83
    v_sin_f32 v92, v88
    v_cos_f32 v88, v88
    v_sin_f32 v93, v89
    v_cos_f32 v89, v89
    v_sin_f32 v94, v90
    v_cos_f32 v90, v90
    v_sin_f32 v95, v91
    v_cos_f32 v91, v91
    v_cvt_pk_bf16_f32 v88, v88, -v92
    v_cvt_pk_bf16_f32 v89, v89, -v93
    v_cvt_pk_bf16_f32 v90, v90, -v94
    v_cvt_pk_bf16_f32 v91, v91, -v95
    v_cndmask_b32 v88, v88, v84, s[70:71]
    v_accvgpr_write_b32 a56, v88
    v_accvgpr_write_b32 a57, v89
    v_accvgpr_write_b32 a58, v90
    v_accvgpr_write_b32 a59, v91
    v_fmamk_f32 v88, v82, 0x3f800000, v83
    v_fmamk_f32 v89, v82, 0x40a00000, v83
    v_fmamk_f32 v90, v82, 0x41100000, v83
    v_fmamk_f32 v91, v82, 0x41500000, v83
    v_sin_f32 v92, v88
    v_cos_f32 v88, v88
    v_sin_f32 v93, v89
    v_cos_f32 v89, v89
    v_sin_f32 v94, v90
    v_cos_f32 v90, v90
    v_sin_f32 v95, v91
    v_cos_f32 v91, v91
    v_cvt_pk_bf16_f32 v88, v88, -v92
    v_cvt_pk_bf16_f32 v89, v89, -v93
    v_cvt_pk_bf16_f32 v90, v90, -v94
    v_cvt_pk_bf16_f32 v91, v91, -v95
    v_accvgpr_write_b32 a72, v88
    v_accvgpr_write_b32 a73, v89
    v_accvgpr_write_b32 a74, v90
    v_accvgpr_write_b32 a75, v91
    v_fmamk_f32 v88, v82, 0x40000000, v83
    v_fmamk_f32 v89, v82, 0x40c00000, v83
    v_fmamk_f32 v90, v82, 0x41200000, v83
    v_fmamk_f32 v91, v82, 0x41600000, v83
    v_sin_f32 v92, v88
    v_cos_f32 v88, v88
    v_sin_f32 v93, v89
    v_cos_f32 v89, v89
    v_sin_f32 v94, v90
    v_cos_f32 v90, v90
    v_sin_f32 v95, v91
    v_cos_f32 v91, v91
    v_cvt_pk_bf16_f32 v88, v88, -v92
    v_cvt_pk_bf16_f32 v89, v89, -v93
    v_cvt_pk_bf16_f32 v90, v90, -v94
    v_cvt_pk_bf16_f32 v91, v91, -v95
    v_accvgpr_write_b32 a88, v88
    v_accvgpr_write_b32 a89, v89
    v_accvgpr_write_b32 a90, v90
    v_accvgpr_write_b32 a91, v91
    v_fmamk_f32 v88, v82, 0x40400000, v83
    v_fmamk_f32 v89, v82, 0x40e00000, v83
    v_fmamk_f32 v90, v82, 0x41300000, v83
    v_fmamk_f32 v91, v82, 0x41700000, v83
    v_sin_f32 v92, v88
    v_cos_f32 v88, v88
    v_sin_f32 v93, v89
    v_cos_f32 v89, v89
    v_sin_f32 v94, v90
    v_cos_f32 v90, v90
    v_sin_f32 v95, v91
    v_cos_f32 v91, v91
    v_cvt_pk_bf16_f32 v88, v88, -v92
    v_cvt_pk_bf16_f32 v89, v89, -v93
    v_cvt_pk_bf16_f32 v90, v90, -v94
    v_cvt_pk_bf16_f32 v91, v91, -v95
    v_accvgpr_write_b32 a104, v88
    v_accvgpr_write_b32 a105, v89
    v_accvgpr_write_b32 a106, v90
    v_accvgpr_write_b32 a107, v91
    v_add_f32 v82, 0x42400000, v80
    v_mul_f32 v82, 0x3b124925, v82
    v_mul_f32 v83, v82, v81
    v_fract_f32 v83, v83
    v_fmamk_f32 v88, v82, 0x00000000, v83
    v_fmamk_f32 v89, v82, 0x40800000, v83
    v_fmamk_f32 v90, v82, 0x41000000, v83
    v_fmamk_f32 v91, v82, 0x41400000, v83
    v_sin_f32 v92, v88
    v_cos_f32 v88, v88
    v_sin_f32 v93, v89
    v_cos_f32 v89, v89
    v_sin_f32 v94, v90
    v_cos_f32 v90, v90
    v_sin_f32 v95, v91
    v_cos_f32 v91, v91
    v_cvt_pk_bf16_f32 v88, v88, -v92
    v_cvt_pk_bf16_f32 v89, v89, -v93
    v_cvt_pk_bf16_f32 v90, v90, -v94
    v_cvt_pk_bf16_f32 v91, v91, -v95
    v_cndmask_b32 v88, v88, v84, s[70:71]
    v_accvgpr_write_b32 a60, v88
    v_accvgpr_write_b32 a61, v89
    v_accvgpr_write_b32 a62, v90
    v_accvgpr_write_b32 a63, v91
    v_fmamk_f32 v88, v82, 0x3f800000, v83
    v_fmamk_f32 v89, v82, 0x40a00000, v83
    v_fmamk_f32 v90, v82, 0x41100000, v83
    v_fmamk_f32 v91, v82, 0x41500000, v83
    v_sin_f32 v92, v88
    v_cos_f32 v88, v88
    v_sin_f32 v93, v89
    v_cos_f32 v89, v89
    v_sin_f32 v94, v90
    v_cos_f32 v90, v90
    v_sin_f32 v95, v91
    v_cos_f32 v91, v91
    v_cvt_pk_bf16_f32 v88, v88, -v92
    v_cvt_pk_bf16_f32 v89, v89, -v93
    v_cvt_pk_bf16_f32 v90, v90, -v94
    v_cvt_pk_bf16_f32 v91, v91, -v95
    v_accvgpr_write_b32 a76, v88
    v_accvgpr_write_b32 a77, v89
    v_accvgpr_write_b32 a78, v90
    v_accvgpr_write_b32 a79, v91
    v_fmamk_f32 v88, v82, 0x40000000, v83
    v_fmamk_f32 v89, v82, 0x40c00000, v83
    v_fmamk_f32 v90, v82, 0x41200000, v83
    v_fmamk_f32 v91, v82, 0x41600000, v83
    v_sin_f32 v92, v88
    v_cos_f32 v88, v88
    v_sin_f32 v93, v89
    v_cos_f32 v89, v89
    v_sin_f32 v94, v90
    v_cos_f32 v90, v90
    v_sin_f32 v95, v91
    v_cos_f32 v91, v91
    v_cvt_pk_bf16_f32 v88, v88, -v92
    v_cvt_pk_bf16_f32 v89, v89, -v93
    v_cvt_pk_bf16_f32 v90, v90, -v94
    v_cvt_pk_bf16_f32 v91, v91, -v95
    v_accvgpr_write_b32 a92, v88
    v_accvgpr_write_b32 a93, v89
    v_accvgpr_write_b32 a94, v90
    v_accvgpr_write_b32 a95, v91
    v_fmamk_f32 v88, v82, 0x40400000, v83
    v_fmamk_f32 v89, v82, 0x40e00000, v83
    v_fmamk_f32 v90, v82, 0x41300000, v83
    v_fmamk_f32 v91, v82, 0x41700000, v83
    v_sin_f32 v92, v88
    v_cos_f32 v88, v88
    v_sin_f32 v93, v89
    v_cos_f32 v89, v89
    v_sin_f32 v94, v90
    v_cos_f32 v90, v90
    v_sin_f32 v95, v91
    v_cos_f32 v91, v91
    v_cvt_pk_bf16_f32 v88, v88, -v92
    v_cvt_pk_bf16_f32 v89, v89, -v93
    v_cvt_pk_bf16_f32 v90, v90, -v94
    v_cvt_pk_bf16_f32 v91, v91, -v95
    v_accvgpr_write_b32 a108, v88
    v_accvgpr_write_b32 a109, v89
    v_accvgpr_write_b32 a110, v90
    v_accvgpr_write_b32 a111, v91
    s_and_b32 s77, s2, 7
    s_lshl_b32 s77, s77, 13
    s_add_u32 s63, s77, 65536
    s_lshl_b32 s77, s72, 2
    v_add_u32 v9, s77, v4
    v_min_u32 v9, 13, v9
    v_cmp_lt_u32 vcc, 6, v9
    v_subrev_u32 v12, 7, v9
    s_nop 0
    v_cndmask_b32 v9, v9, v12, vcc
    v_lshlrev_b32 v9, 10, v9
    v_cndmask_b32 v12, 0, 16, vcc
    v_add_u32 v9, v9, v12
    v_and_b32 v12, 3, v1
    v_lshl_add_u32 v9, v12, 8, v9
    v_bfe_u32 v12, v1, 2, 2
    v_lshl_add_u32 v9, v12, 5, v9
    s_and_b32 s77, s72, 1
    s_lshl_b32 s77, s77, 6
    v_lshlrev_b32 v10, 4, v8
    v_xor_b32 v10, s77, v10
    s_movk_i32 s77, 7168
    v_mad_u32_u24 v10, v4, s77, v10
    s_lshl_b32 s66, s72, 9
    s_add_u32 s66, s66, 2883584
    s_cmp_eq_u32 s72, 3
    s_movk_i32 s67, 256
    s_cselect_b32 s67, 0x40000000, s67
    s_mul_i32 s77, s53, 28672
    s_add_u32 s54, s77, s66
    s_add_u32 s55, s54, s67
    s_mul_i32 s77, s52, 28672
    s_add_u32 s52, s77, s66
    s_add_u32 s53, s52, s67
    s_add_u32 s68, s52, 3584
    s_add_u32 s69, s53, 3584
    s_add_u32 s70, s54, 3584
    s_add_u32 s71, s55, 3584
    ds_read_b128 v[28:31], v27 offset:32
    s_waitcnt lgkmcnt(0)
    v_min_u32 v28, v28, v29
    v_min3_u32 v28, v28, v30, v31
    v_cmp_gt_u32 vcc, 4, v28
    s_nop 0
    s_cmp_eq_u64 vcc, 0
    s_cbranch_scc1 L_pd24
    s_mov_b32 s96, 300000
L_pl24:
    s_sleep 1
    ds_read_b128 v[28:31], v27 offset:32
    s_waitcnt lgkmcnt(0)
    v_min_u32 v28, v28, v29
    v_min3_u32 v28, v28, v30, v31
    v_cmp_gt_u32 vcc, 4, v28
    s_sub_u32 s96, s96, 1
    s_cmp_eq_u32 s96, 0
    s_cbranch_scc1 L_pd24
    s_cmp_eq_u64 vcc, 0
    s_cbranch_scc0 L_pl24
L_pd24:
    s_setprio 0
    buffer_load_dword v12, v9, s[16:19], s63 offen sc1
    buffer_load_dword v13, v9, s[16:19], s63 offen offset:128 sc1
    s_waitcnt vmcnt(0)
    v_subrev_u32 v12, s73, v12
    v_subrev_u32 v13, s73, v13
    v_max_u32 v12, v12, v13
    v_cmp_le_u32 vcc, 1, v12
    s_nop 0
    s_cmp_eq_u64 vcc, 0
    s_cbranch_scc1 L_pd25
    s_mov_b32 s96, 300000
L_pl25:
    s_sleep 10
    buffer_load_dword v12, v9, s[16:19], s63 offen sc1
    buffer_load_dword v13, v9, s[16:19], s63 offen offset:128 sc1
    s_waitcnt vmcnt(0)
    v_subrev_u32 v12, s73, v12
    v_subrev_u32 v13, s73, v13
    v_max_u32 v12, v12, v13
    v_cmp_le_u32 vcc, 1, v12
    s_sub_u32 s96, s96, 1
    s_cmp_eq_u32 s96, 0
    s_cbranch_scc1 L_pd25
    s_cmp_eq_u64 vcc, 0
    s_cbranch_scc0 L_pl25
L_pd25:
    buffer_load_dwordx4 a[0:3], v10, s[16:19], s52 offen offset:0 sc1
    buffer_load_dwordx4 a[4:7], v10, s[16:19], s52 offen offset:1792 sc1
    buffer_load_dwordx4 a[8:11], v10, s[16:19], s68 offen offset:0 sc1
    buffer_load_dwordx4 a[12:15], v10, s[16:19], s68 offen offset:1792 sc1
    buffer_load_dwordx4 a[16:19], v10, s[16:19], s53 offen offset:0 sc1
    buffer_load_dwordx4 a[20:23], v10, s[16:19], s53 offen offset:1792 sc1
    buffer_load_dwordx4 a[24:27], v10, s[16:19], s69 offen offset:0 sc1
    buffer_load_dwordx4 a[28:31], v10, s[16:19], s69 offen offset:1792 sc1
    buffer_load_dwordx4 a[32:35], v10, s[16:19], s54 offen offset:0 sc1
    buffer_load_dwordx4 a[36:39], v10, s[16:19], s54 offen offset:1792 sc1
    buffer_load_dwordx4 a[40:43], v10, s[16:19], s70 offen offset:0 sc1
    buffer_load_dwordx4 a[44:47], v10, s[16:19], s70 offen offset:1792 sc1
    buffer_load_dwordx4 v[112:115], v10, s[16:19], s55 offen offset:0 sc1
    buffer_load_dwordx4 v[116:119], v10, s[16:19], s55 offen offset:1792 sc1
    buffer_load_dwordx4 v[120:123], v10, s[16:19], s71 offen offset:0 sc1
    buffer_load_dwordx4 v[124:127], v10, s[16:19], s71 offen offset:1792 sc1
    s_xor_b32 s77, s46, 1
    s_mul_i32 s77, s77, 7
    s_add_u32 s77, s77, s47
    s_lshl_b32 s78, s44, 4
    s_add_u32 s77, s77, s78
    s_lshl_b32 s77, s77, 2
    s_add_u32 s77, s77, s72
    s_lshl_b32 s61, s77, 12
    s_add_u32 s61, s61, 12058624
    s_waitcnt vmcnt(15)
    v_accvgpr_read_b32 v128, a0
    s_waitcnt vmcnt(14)
    v_accvgpr_read_b32 v129, a4
    s_waitcnt vmcnt(13)
    v_accvgpr_read_b32 v130, a8
    s_waitcnt vmcnt(12)
    v_accvgpr_read_b32 v131, a12
    s_waitcnt vmcnt(11)
    v_accvgpr_read_b32 v132, a16
    s_waitcnt vmcnt(10)
    v_accvgpr_read_b32 v133, a20
    s_waitcnt vmcnt(9)
    v_accvgpr_read_b32 v134, a24
    s_waitcnt vmcnt(8)
    v_accvgpr_read_b32 v135, a28
    v_mfma_f32_16x16x32_bf16 v[12:15], v[128:131], v[96:99], 0
    v_mfma_f32_16x16x32_bf16 v[16:19], v[128:131], v[100:103], 0
    v_mfma_f32_16x16x32_bf16 v[20:23], v[132:135], v[96:99], 0
    v_mfma_f32_16x16x32_bf16 v[28:31], v[132:135], v[100:103], 0
    v_accvgpr_read_b32 v136, a1
    v_accvgpr_read_b32 v137, a5
    v_accvgpr_read_b32 v138, a9
    v_accvgpr_read_b32 v139, a13
    v_accvgpr_read_b32 v140, a17
    v_accvgpr_read_b32 v141, a21
    v_accvgpr_read_b32 v142, a25
    v_accvgpr_read_b32 v143, a29
    v_cvt_pk_bf16_f32 v128, v12, v16
    v_cvt_pk_bf16_f32 v129, v13, v17
    v_cvt_pk_bf16_f32 v130, v14, v18
    v_cvt_pk_bf16_f32 v131, v15, v19
    v_cvt_pk_bf16_f32 v132, v20, v28
    v_cvt_pk_bf16_f32 v133, v21, v29
    v_cvt_pk_bf16_f32 v134, v22, v30
    v_cvt_pk_bf16_f32 v135, v23, v31
    v_permlane16_swap_b32 v128, v132
    v_permlane16_swap_b32 v129, v133
    v_permlane16_swap_b32 v130, v134
    v_permlane16_swap_b32 v131, v135
    v_mfma_f32_16x16x32_bf16 v[12:15], v[136:139], v[96:99], 0
    v_mfma_f32_16x16x32_bf16 v[16:19], v[136:139], v[100:103], 0
    v_mfma_f32_16x16x32_bf16 v[20:23], v[140:143], v[96:99], 0
    v_mfma_f32_16x16x32_bf16 v[28:31], v[140:143], v[100:103], 0
    v_mfma_f32_16x16x32_bf16 v[80:83], a[48:51], v[132:135], 0
    v_mfma_f32_16x16x32_bf16 v[84:87], a[52:55], v[132:135], 0
    v_mfma_f32_16x16x32_bf16 v[88:91], a[56:59], v[132:135], 0
    s_nop 2
    v_cvt_pk_bf16_f32 v136, v12, v16
    v_cvt_pk_bf16_f32 v137, v13, v17
    v_mfma_f32_16x16x32_bf16 v[92:95], a[60:63], v[132:135], 0
    v_cvt_pk_bf16_f32 v138, v14, v18
    v_cvt_pk_bf16_f32 v139, v15, v19
    v_mfma_f32_16x16x32_bf16 v[64:67], a[48:51], v[128:131], 0
    v_cvt_pk_bf16_f32 v140, v20, v28
    v_cvt_pk_bf16_f32 v141, v21, v29
    v_accvgpr_read_b32 v132, a18
    v_mfma_f32_16x16x32_bf16 v[68:71], a[52:55], v[128:131], 0
    v_cvt_pk_bf16_f32 v142, v22, v30
    v_cvt_pk_bf16_f32 v143, v23, v31
    v_accvgpr_read_b32 v133, a22
    v_mfma_f32_16x16x32_bf16 v[72:75], a[56:59], v[128:131], 0
    v_permlane16_swap_b32 v136, v140
    v_permlane16_swap_b32 v137, v141
    v_accvgpr_read_b32 v134, a26
    v_mfma_f32_16x16x32_bf16 v[76:79], a[60:63], v[128:131], 0
    v_permlane16_swap_b32 v138, v142
    v_permlane16_swap_b32 v139, v143
    v_accvgpr_read_b32 v135, a30
    v_accvgpr_read_b32 v128, a2
    v_accvgpr_read_b32 v129, a6
    v_accvgpr_read_b32 v130, a10
    v_accvgpr_read_b32 v131, a14
    s_nop 1
    v_mfma_f32_16x16x32_bf16 v[12:15], v[128:131], v[96:99], 0
    v_mfma_f32_16x16x32_bf16 v[16:19], v[128:131], v[100:103], 0
    v_mfma_f32_16x16x32_bf16 v[20:23], v[132:135], v[96:99], 0
    v_mfma_f32_16x16x32_bf16 v[28:31], v[132:135], v[100:103], 0
    v_mfma_f32_16x16x32_bf16 v[80:83], a[64:67], v[140:143], v[80:83]
    v_mfma_f32_16x16x32_bf16 v[84:87], a[68:71], v[140:143], v[84:87]
    v_mfma_f32_16x16x32_bf16 v[88:91], a[72:75], v[140:143], v[88:91]
    s_nop 2
    v_cvt_pk_bf16_f32 v128, v12, v16
    v_cvt_pk_bf16_f32 v129, v13, v17
    v_mfma_f32_16x16x32_bf16 v[92:95], a[76:79], v[140:143], v[92:95]
    v_cvt_pk_bf16_f32 v130, v14, v18
    v_cvt_pk_bf16_f32 v131, v15, v19
    v_mfma_f32_16x16x32_bf16 v[64:67], a[64:67], v[136:139], v[64:67]
    v_cvt_pk_bf16_f32 v132, v20, v28
    v_cvt_pk_bf16_f32 v133, v21, v29
    v_accvgpr_read_b32 v140, a19
    v_mfma_f32_16x16x32_bf16 v[68:71], a[68:71], v[136:139], v[68:71]
    v_cvt_pk_bf16_f32 v134, v22, v30
    v_cvt_pk_bf16_f32 v135, v23, v31
    v_accvgpr_read_b32 v141, a23
    v_mfma_f32_16x16x32_bf16 v[72:75], a[72:75], v[136:139], v[72:75]
    v_permlane16_swap_b32 v128, v132
    v_permlane16_swap_b32 v129, v133
    v_accvgpr_read_b32 v142, a27
    v_mfma_f32_16x16x32_bf16 v[76:79], a[76:79], v[136:139], v[76:79]
    v_permlane16_swap_b32 v130, v134
    v_permlane16_swap_b32 v131, v135
    v_accvgpr_read_b32 v143, a31
    v_accvgpr_read_b32 v136, a3
    v_accvgpr_read_b32 v137, a7
    v_accvgpr_read_b32 v138, a11
    v_accvgpr_read_b32 v139, a15
    s_nop 1
    v_mfma_f32_16x16x32_bf16 v[12:15], v[136:139], v[96:99], 0
    v_mfma_f32_16x16x32_bf16 v[16:19], v[136:139], v[100:103], 0
    v_mfma_f32_16x16x32_bf16 v[20:23], v[140:143], v[96:99], 0
    v_mfma_f32_16x16x32_bf16 v[28:31], v[140:143], v[100:103], 0
    v_mfma_f32_16x16x32_bf16 v[80:83], a[80:83], v[132:135], v[80:83]
    v_mfma_f32_16x16x32_bf16 v[84:87], a[84:87], v[132:135], v[84:87]
    v_mfma_f32_16x16x32_bf16 v[88:91], a[88:91], v[132:135], v[88:91]
    s_nop 2
    v_cvt_pk_bf16_f32 v136, v12, v16
    v_cvt_pk_bf16_f32 v137, v13, v17
    v_mfma_f32_16x16x32_bf16 v[92:95], a[92:95], v[132:135], v[92:95]
    v_cvt_pk_bf16_f32 v138, v14, v18
    v_cvt_pk_bf16_f32 v139, v15, v19
    v_mfma_f32_16x16x32_bf16 v[64:67], a[80:83], v[128:131], v[64:67]
    v_cvt_pk_bf16_f32 v140, v20, v28
    v_cvt_pk_bf16_f32 v141, v21, v29
    s_waitcnt vmcnt(3)
    v_mov_b32 v132, v112
    v_mfma_f32_16x16x32_bf16 v[68:71], a[84:87], v[128:131], v[68:71]
    v_cvt_pk_bf16_f32 v142, v22, v30
    v_cvt_pk_bf16_f32 v143, v23, v31
    s_waitcnt vmcnt(2)
    v_mov_b32 v133, v116
    v_mfma_f32_16x16x32_bf16 v[72:75], a[88:91], v[128:131], v[72:75]
    v_permlane16_swap_b32 v136, v140
    v_permlane16_swap_b32 v137, v141
    s_waitcnt vmcnt(1)
    v_mov_b32 v134, v120
    v_mfma_f32_16x16x32_bf16 v[76:79], a[92:95], v[128:131], v[76:79]
    v_permlane16_swap_b32 v138, v142
    v_permlane16_swap_b32 v139, v143
    s_waitcnt vmcnt(0)
    v_mov_b32 v135, v124
    v_accvgpr_read_b32 v128, a32
    v_accvgpr_read_b32 v129, a36
    v_accvgpr_read_b32 v130, a40
    v_accvgpr_read_b32 v131, a44
    s_nop 1
    v_mfma_f32_16x16x32_bf16 v[12:15], v[128:131], v[104:107], 0
    v_mfma_f32_16x16x32_bf16 v[16:19], v[128:131], v[108:111], 0
    v_mfma_f32_16x16x32_bf16 v[20:23], v[132:135], v[104:107], 0
    v_mfma_f32_16x16x32_bf16 v[28:31], v[132:135], v[108:111], 0
    v_mfma_f32_16x16x32_bf16 v[80:83], a[96:99], v[140:143], v[80:83]
    v_mfma_f32_16x16x32_bf16 v[84:87], a[100:103], v[140:143], v[84:87]
    v_mfma_f32_16x16x32_bf16 v[88:91], a[104:107], v[140:143], v[88:91]
    s_nop 2
    v_cvt_pk_bf16_f32 v128, v12, v16
    v_cvt_pk_bf16_f32 v129, v13, v17
    v_mfma_f32_16x16x32_bf16 v[92:95], a[108:111], v[140:143], v[92:95]
    v_cvt_pk_bf16_f32 v130, v14, v18
    v_cvt_pk_bf16_f32 v131, v15, v19
    v_mfma_f32_16x16x32_bf16 v[64:67], a[96:99], v[136:139], v[64:67]
    v_cvt_pk_bf16_f32 v132, v20, v28
    v_cvt_pk_bf16_f32 v133, v21, v29
    v_mov_b32 v140, v113
    v_mfma_f32_16x16x32_bf16 v[68:71], a[100:103], v[136:139], v[68:71]
    v_cvt_pk_bf16_f32 v134, v22, v30
    v_cvt_pk_bf16_f32 v135, v23, v31
    v_mov_b32 v141, v117
    v_mfma_f32_16x16x32_bf16 v[72:75], a[104:107], v[136:139], v[72:75]
    v_permlane16_swap_b32 v128, v132
    v_permlane16_swap_b32 v129, v133
    v_mov_b32 v142, v121
    v_mfma_f32_16x16x32_bf16 v[76:79], a[108:111], v[136:139], v[76:79]
    v_permlane16_swap_b32 v130, v134
    v_permlane16_swap_b32 v131, v135
    v_mov_b32 v143, v125
    v_accvgpr_read_b32 v136, a33
    v_accvgpr_read_b32 v137, a37
    v_accvgpr_read_b32 v138, a41
    v_accvgpr_read_b32 v139, a45
    s_nop 1
    v_mfma_f32_16x16x32_bf16 v[12:15], v[136:139], v[104:107], 0
    v_mfma_f32_16x16x32_bf16 v[16:19], v[136:139], v[108:111], 0
    v_mfma_f32_16x16x32_bf16 v[20:23], v[140:143], v[104:107], 0
    v_mfma_f32_16x16x32_bf16 v[28:31], v[140:143], v[108:111], 0
    v_mfma_f32_16x16x32_bf16 v[48:51], a[48:51], v[132:135], 0
    v_mfma_f32_16x16x32_bf16 v[52:55], a[52:55], v[132:135], 0
    v_mfma_f32_16x16x32_bf16 v[56:59], a[56:59], v[132:135], 0
    s_nop 2
    v_cvt_pk_bf16_f32 v136, v12, v16
    v_cvt_pk_bf16_f32 v137, v13, v17
    v_mfma_f32_16x16x32_bf16 v[60:63], a[60:63], v[132:135], 0
    v_cvt_pk_bf16_f32 v138, v14, v18
    v_cvt_pk_bf16_f32 v139, v15, v19
    v_mfma_f32_16x16x32_bf16 v[32:35], a[48:51], v[128:131], 0
    v_cvt_pk_bf16_f32 v140, v20, v28
    v_cvt_pk_bf16_f32 v141, v21, v29
    v_mov_b32 v132, v114
    v_mfma_f32_16x16x32_bf16 v[36:39], a[52:55], v[128:131], 0
    v_cvt_pk_bf16_f32 v142, v22, v30
    v_cvt_pk_bf16_f32 v143, v23, v31
    v_mov_b32 v133, v118
    v_mfma_f32_16x16x32_bf16 v[40:43], a[56:59], v[128:131], 0
    v_permlane16_swap_b32 v136, v140
    v_permlane16_swap_b32 v137, v141
    v_mov_b32 v134, v122
    v_mfma_f32_16x16x32_bf16 v[44:47], a[60:63], v[128:131], 0
    v_permlane16_swap_b32 v138, v142
    v_permlane16_swap_b32 v139, v143
    v_mov_b32 v135, v126
    v_accvgpr_read_b32 v128, a34
    v_accvgpr_read_b32 v129, a38
    v_accvgpr_read_b32 v130, a42
    v_accvgpr_read_b32 v131, a46
    s_nop 1
    v_mfma_f32_16x16x32_bf16 v[12:15], v[128:131], v[104:107], 0
    s_xor_b32 s77, s72, 2
    s_mul_i32 s77, s77, 6144
    s_add_u32 s77, s77, 92160
    v_mfma_f32_16x16x32_bf16 v[16:19], v[128:131], v[108:111], 0
    v_add_u32 v9, s77, v7
    v_cvt_pk_bf16_f32 v64, v64, v65
    v_mfma_f32_16x16x32_bf16 v[20:23], v[132:135], v[104:107], 0
    v_cvt_pk_bf16_f32 v65, v66, v67
    v_cvt_pk_bf16_f32 v66, v68, v69
    v_mfma_f32_16x16x32_bf16 v[28:31], v[132:135], v[108:111], 0
    v_cvt_pk_bf16_f32 v67, v70, v71
    v_cvt_pk_bf16_f32 v68, v72, v73
    v_cvt_pk_bf16_f32 v69, v74, v75
    v_mfma_f32_16x16x32_bf16 v[48:51], a[64:67], v[140:143], v[48:51]
    v_cvt_pk_bf16_f32 v70, v76, v77
    v_cvt_pk_bf16_f32 v71, v78, v79
    v_mfma_f32_16x16x32_bf16 v[52:55], a[68:71], v[140:143], v[52:55]
    ds_write_b128 v9, v[64:67]
    ds_write_b128 v9, v[68:71] offset:1024
    v_mfma_f32_16x16x32_bf16 v[56:59], a[72:75], v[140:143], v[56:59]
    v_cvt_pk_bf16_f32 v128, v12, v16
    v_cvt_pk_bf16_f32 v129, v13, v17
    v_mfma_f32_16x16x32_bf16 v[60:63], a[76:79], v[140:143], v[60:63]
    v_cvt_pk_bf16_f32 v130, v14, v18
    v_cvt_pk_bf16_f32 v131, v15, v19
    v_mfma_f32_16x16x32_bf16 v[32:35], a[64:67], v[136:139], v[32:35]
    v_cvt_pk_bf16_f32 v132, v20, v28
    v_cvt_pk_bf16_f32 v133, v21, v29
    v_mov_b32 v140, v115
    v_mfma_f32_16x16x32_bf16 v[36:39], a[68:71], v[136:139], v[36:39]
    v_cvt_pk_bf16_f32 v134, v22, v30
    v_cvt_pk_bf16_f32 v135, v23, v31
    v_mov_b32 v141, v119
    v_mfma_f32_16x16x32_bf16 v[40:43], a[72:75], v[136:139], v[40:43]
    v_permlane16_swap_b32 v128, v132
    v_permlane16_swap_b32 v129, v133
    v_mov_b32 v142, v123
    v_mfma_f32_16x16x32_bf16 v[44:47], a[76:79], v[136:139], v[44:47]
    v_permlane16_swap_b32 v130, v134
    v_permlane16_swap_b32 v131, v135
    v_mov_b32 v143, v127
    v_accvgpr_read_b32 v136, a35
    v_accvgpr_read_b32 v137, a39
    v_accvgpr_read_b32 v138, a43
    v_accvgpr_read_b32 v139, a47
    s_nop 1
    v_mfma_f32_16x16x32_bf16 v[12:15], v[136:139], v[104:107], 0
    s_xor_b32 s77, s72, 3
    s_mul_i32 s77, s77, 6144
    s_add_u32 s77, s77, 94208
    v_mfma_f32_16x16x32_bf16 v[16:19], v[136:139], v[108:111], 0
    v_add_u32 v9, s77, v7
    v_cvt_pk_bf16_f32 v80, v80, v81
    v_mfma_f32_16x16x32_bf16 v[20:23], v[140:143], v[104:107], 0
    v_cvt_pk_bf16_f32 v81, v82, v83
    v_cvt_pk_bf16_f32 v82, v84, v85
    v_mfma_f32_16x16x32_bf16 v[28:31], v[140:143], v[108:111], 0
    v_cvt_pk_bf16_f32 v83, v86, v87
    v_cvt_pk_bf16_f32 v84, v88, v89
    v_cvt_pk_bf16_f32 v85, v90, v91
    v_mfma_f32_16x16x32_bf16 v[48:51], a[80:83], v[132:135], v[48:51]
    v_cvt_pk_bf16_f32 v86, v92, v93
    v_cvt_pk_bf16_f32 v87, v94, v95
    v_mfma_f32_16x16x32_bf16 v[52:55], a[84:87], v[132:135], v[52:55]
    ds_write_b128 v9, v[80:83]
    ds_write_b128 v9, v[84:87] offset:1024
    v_mfma_f32_16x16x32_bf16 v[56:59], a[88:91], v[132:135], v[56:59]
    v_cvt_pk_bf16_f32 v136, v12, v16
    v_cvt_pk_bf16_f32 v137, v13, v17
    v_mfma_f32_16x16x32_bf16 v[60:63], a[92:95], v[132:135], v[60:63]
    v_cvt_pk_bf16_f32 v138, v14, v18
    v_cvt_pk_bf16_f32 v139, v15, v19
    v_mfma_f32_16x16x32_bf16 v[32:35], a[80:83], v[128:131], v[32:35]
    v_cvt_pk_bf16_f32 v140, v20, v28
    v_cvt_pk_bf16_f32 v141, v21, v29
    v_mfma_f32_16x16x32_bf16 v[36:39], a[84:87], v[128:131], v[36:39]
    v_cvt_pk_bf16_f32 v142, v22, v30
    v_cvt_pk_bf16_f32 v143, v23, v31
    v_mfma_f32_16x16x32_bf16 v[40:43], a[88:91], v[128:131], v[40:43]
    v_permlane16_swap_b32 v136, v140
    v_permlane16_swap_b32 v137, v141
    v_mfma_f32_16x16x32_bf16 v[44:47], a[92:95], v[128:131], v[44:47]
    v_permlane16_swap_b32 v138, v142
    v_permlane16_swap_b32 v139, v143
    s_nop 1
    v_mfma_f32_16x16x32_bf16 v[48:51], a[96:99], v[140:143], v[48:51]
    v_lshlrev_b32 v10, 3, v4
    s_lshl_b32 s77, s47, 7
    buffer_load_dwordx2 v[88:89], v10, s[40:43], s77 offen offset:0
    v_mfma_f32_16x16x32_bf16 v[52:55], a[100:103], v[140:143], v[52:55]
    buffer_load_dwordx2 v[90:91], v10, s[40:43], s77 offen offset:32
    buffer_load_dwordx2 v[92:93], v10, s[40:43], s77 offen offset:64
    buffer_load_dwordx2 v[94:95], v10, s[40:43], s77 offen offset:96
    v_mfma_f32_16x16x32_bf16 v[56:59], a[104:107], v[140:143], v[56:59]
    v_mfma_f32_16x16x32_bf16 v[60:63], a[108:111], v[140:143], v[60:63]
    v_mfma_f32_16x16x32_bf16 v[32:35], a[96:99], v[136:139], v[32:35]
    v_mfma_f32_16x16x32_bf16 v[36:39], a[100:103], v[136:139], v[36:39]
    v_mfma_f32_16x16x32_bf16 v[40:43], a[104:107], v[136:139], v[40:43]
    v_mfma_f32_16x16x32_bf16 v[44:47], a[108:111], v[136:139], v[44:47]
    s_xor_b32 s77, s72, 1
    s_mul_i32 s77, s77, 6144
    s_add_u32 s77, s77, 90112
    v_add_u32 v9, s77, v7
    v_cvt_pk_bf16_f32 v48, v48, v49
    v_cvt_pk_bf16_f32 v49, v50, v51
    v_cvt_pk_bf16_f32 v50, v52, v53
    v_cvt_pk_bf16_f32 v51, v54, v55
    v_cvt_pk_bf16_f32 v52, v56, v57
    v_cvt_pk_bf16_f32 v53, v58, v59
    v_cvt_pk_bf16_f32 v54, v60, v61
    v_cvt_pk_bf16_f32 v55, v62, v63
    ds_write_b128 v9, v[48:51]
    ds_write_b128 v9, v[52:55] offset:1024
    v_mov_b32 v28, 11
    ds_write_b32 v26, v28 offset:16
    ds_read_b128 v[28:31], v27 offset:16
    s_waitcnt lgkmcnt(0)
    v_min_u32 v28, v28, v29
    v_min3_u32 v28, v28, v30, v31
    v_cmp_gt_u32 vcc, 11, v28
    s_nop 0
    s_cmp_eq_u64 vcc, 0
    s_cbranch_scc1 L_pd26
    s_mov_b32 s96, 300000
L_pl26:
    s_sleep 1
    ds_read_b128 v[28:31], v27 offset:16
    s_waitcnt lgkmcnt(0)
    v_min_u32 v28, v28, v29
    v_min3_u32 v28, v28, v30, v31
    v_cmp_gt_u32 vcc, 11, v28
    s_sub_u32 s96, s96, 1
    s_cmp_eq_u32 s96, 0
    s_cbranch_scc1 L_pd26
    s_cmp_eq_u64 vcc, 0
    s_cbranch_scc0 L_pl26
L_pd26:
    s_mul_i32 s77, s72, 6144
    s_add_u32 s77, s77, 90112
    v_add_u32 v9, s77, v7
    ds_read_b128 v[96:99], v9 offset:0
    ds_read_b128 v[100:103], v9 offset:1024
    ds_read_b128 v[104:107], v9 offset:2048
    ds_read_b128 v[108:111], v9 offset:3072
    ds_read_b128 v[112:115], v9 offset:4096
    ds_read_b128 v[116:119], v9 offset:5120
    s_waitcnt lgkmcnt(5)
    v_lshlrev_b32 v128, 16, v96
    v_and_b32 v129, 0xffff0000, v96
    v_lshlrev_b32 v130, 16, v97
    v_and_b32 v131, 0xffff0000, v97
    v_lshlrev_b32 v132, 16, v98
    v_and_b32 v133, 0xffff0000, v98
    v_lshlrev_b32 v134, 16, v99
    v_and_b32 v135, 0xffff0000, v99
    s_waitcnt lgkmcnt(4)
    v_lshlrev_b32 v136, 16, v100
    v_and_b32 v137, 0xffff0000, v100
    v_lshlrev_b32 v138, 16, v101
    v_and_b32 v139, 0xffff0000, v101
    v_lshlrev_b32 v140, 16, v102
    v_and_b32 v141, 0xffff0000, v102
    v_lshlrev_b32 v142, 16, v103
    v_and_b32 v143, 0xffff0000, v103
    v_add_f32 v32, v32, v128
    v_add_f32 v33, v33, v129
    v_add_f32 v34, v34, v130
    v_add_f32 v35, v35, v131
    v_add_f32 v36, v36, v132
    v_add_f32 v37, v37, v133
    v_add_f32 v38, v38, v134
    v_add_f32 v39, v39, v135
    v_add_f32 v40, v40, v136
    v_add_f32 v41, v41, v137
    v_add_f32 v42, v42, v138
    v_add_f32 v43, v43, v139
    v_add_f32 v44, v44, v140
    v_add_f32 v45, v45, v141
    v_add_f32 v46, v46, v142
    v_add_f32 v47, v47, v143
    s_waitcnt lgkmcnt(3)
    v_lshlrev_b32 v128, 16, v104
    v_and_b32 v129, 0xffff0000, v104
    v_lshlrev_b32 v130, 16, v105
    v_and_b32 v131, 0xffff0000, v105
    v_lshlrev_b32 v132, 16, v106
    v_and_b32 v133, 0xffff0000, v106
    v_lshlrev_b32 v134, 16, v107
    v_and_b32 v135, 0xffff0000, v107
    s_waitcnt lgkmcnt(2)
    v_lshlrev_b32 v136, 16, v108
    v_and_b32 v137, 0xffff0000, v108
    v_lshlrev_b32 v138, 16, v109
    v_and_b32 v139, 0xffff0000, v109
    v_lshlrev_b32 v140, 16, v110
    v_and_b32 v141, 0xffff0000, v110
    v_lshlrev_b32 v142, 16, v111
    v_and_b32 v143, 0xffff0000, v111
    v_add_f32 v32, v32, v128
    v_add_f32 v33, v33, v129
    v_add_f32 v34, v34, v130
    v_add_f32 v35, v35, v131
    v_add_f32 v36, v36, v132
    v_add_f32 v37, v37, v133
    v_add_f32 v38, v38, v134
    v_add_f32 v39, v39, v135
    v_add_f32 v40, v40, v136
    v_add_f32 v41, v41, v137
    v_add_f32 v42, v42, v138
    v_add_f32 v43, v43, v139
    v_add_f32 v44, v44, v140
    v_add_f32 v45, v45, v141
    v_add_f32 v46, v46, v142
    v_add_f32 v47, v47, v143
    s_waitcnt lgkmcnt(1)
    v_lshlrev_b32 v128, 16, v112
    v_and_b32 v129, 0xffff0000, v112
    v_lshlrev_b32 v130, 16, v113
    v_and_b32 v131, 0xffff0000, v113
    v_lshlrev_b32 v132, 16, v114
    v_and_b32 v133, 0xffff0000, v114
    v_lshlrev_b32 v134, 16, v115
    v_and_b32 v135, 0xffff0000, v115
    s_waitcnt lgkmcnt(0)
    v_lshlrev_b32 v136, 16, v116
    v_and_b32 v137, 0xffff0000, v116
    v_lshlrev_b32 v138, 16, v117
    v_and_b32 v139, 0xffff0000, v117
    v_lshlrev_b32 v140, 16, v118
    v_and_b32 v141, 0xffff0000, v118
    v_lshlrev_b32 v142, 16, v119
    v_and_b32 v143, 0xffff0000, v119
    v_add_f32 v32, v32, v128
    v_add_f32 v33, v33, v129
    v_add_f32 v34, v34, v130
    v_add_f32 v35, v35, v131
    v_add_f32 v36, v36, v132
    v_add_f32 v37, v37, v133
    v_add_f32 v38, v38, v134
    v_add_f32 v39, v39, v135
    v_add_f32 v40, v40, v136
    v_add_f32 v41, v41, v137
    v_add_f32 v42, v42, v138
    v_add_f32 v43, v43, v139
    v_add_f32 v44, v44, v140
    v_add_f32 v45, v45, v141
    v_add_f32 v46, v46, v142
    v_add_f32 v47, v47, v143
    v_mul_f32 v32, v25, v32
    v_mul_f32 v33, v25, v33
    v_mul_f32 v34, v25, v34
    v_mul_f32 v35, v25, v35
    v_mul_f32 v36, v25, v36
    v_mul_f32 v37, v25, v37
    v_mul_f32 v38, v25, v38
    v_mul_f32 v39, v25, v39
    v_mul_f32 v40, v25, v40
    v_mul_f32 v41, v25, v41
    v_mul_f32 v42, v25, v42
    v_mul_f32 v43, v25, v43
    v_mul_f32 v44, v25, v44
    v_mul_f32 v45, v25, v45
    v_mul_f32 v46, v25, v46
    v_mul_f32 v47, v25, v47
    s_waitcnt vmcnt(3)
    v_lshlrev_b32 v128, 16, v88
    v_and_b32 v129, 0xffff0000, v88
    v_lshlrev_b32 v130, 16, v89
    v_and_b32 v131, 0xffff0000, v89
    s_waitcnt vmcnt(2)
    v_lshlrev_b32 v132, 16, v90
    v_and_b32 v133, 0xffff0000, v90
    v_lshlrev_b32 v134, 16, v91
    v_and_b32 v135, 0xffff0000, v91
    s_waitcnt vmcnt(1)
    v_lshlrev_b32 v136, 16, v92
    v_and_b32 v137, 0xffff0000, v92
    v_lshlrev_b32 v138, 16, v93
    v_and_b32 v139, 0xffff0000, v93
    s_waitcnt vmcnt(0)
    v_lshlrev_b32 v140, 16, v94
    v_and_b32 v141, 0xffff0000, v94
    v_lshlrev_b32 v142, 16, v95
    v_and_b32 v143, 0xffff0000, v95
    v_fmac_f32 v32, v11, v128
    v_fmac_f32 v33, v11, v129
    v_fmac_f32 v34, v11, v130
    v_fmac_f32 v35, v11, v131
    v_fmac_f32 v36, v11, v132
    v_fmac_f32 v37, v11, v133
    v_fmac_f32 v38, v11, v134
    v_fmac_f32 v39, v11, v135
    v_fmac_f32 v40, v11, v136
    v_fmac_f32 v41, v11, v137
    v_fmac_f32 v42, v11, v138
    v_fmac_f32 v43, v11, v139
    v_fmac_f32 v44, v11, v140
    v_fmac_f32 v45, v11, v141
    v_fmac_f32 v46, v11, v142
    v_fmac_f32 v47, v11, v143
    ds_write_b128 v9, v[32:35] offset:0
    ds_write_b128 v9, v[36:39] offset:1024
    ds_write_b128 v9, v[40:43] offset:2048
    ds_write_b128 v9, v[44:47] offset:3072
    s_waitcnt lgkmcnt(0)
    s_barrier
    s_endpgm
L_aux:
    s_and_b32 s44, s2, 1
    s_bfe_u32 s45, s2, 0x20001
    s_bfe_u32 s46, s2, 0x20003
    s_lshl_b32 s46, s46, 3
    s_add_u32 s46, s46, s79
    v_lshrrev_b32 v2, 4, v1
    v_and_b32 v3, 15, v1
    v_min_u32 v3, 13, v3
    v_lshlrev_b32 v3, 7, v3
    s_movk_i32 s77, 3584
    v_mad_u32_u24 v2, v2, s77, v3
    v_lshlrev_b32 v4, 7, v1
    v_lshrrev_b32 v5, 4, v1
    v_bfe_u32 v6, v1, 2, 2
    v_lshl_add_u32 v5, v5, 4, v6
    v_mul_u32_u24 v5, 450, v5
    v_and_b32 v6, 3, v1
    v_lshlrev_b32 v6, 7, v6
    v_min_u32 v6, 224, v6
    v_add_u32 v5, v5, v6
    s_mul_i32 s47, s44, 1792
    s_mul_i32 s77, s46, 14336
    s_add_u32 s47, s47, s77
    s_mul_i32 s72, s44, 802816
    s_lshl_b32 s77, s46, 13
    s_add_u32 s72, s72, s77
    s_lshl_b32 s73, s46, 6
    s_lshl_b32 s77, s45, 2
    s_add_u32 s73, s73, s77
    s_mul_i32 s73, s73, 450
    s_mul_i32 s77, s44, 224
    s_add_u32 s73, s73, s77
    s_waitcnt lgkmcnt(0)
    s_mov_b32 s8, s56
    s_mov_b32 s9, s57
    s_mov_b32 s10, 1605632
    s_mov_b32 s11, 0x20000
    s_mov_b32 s12, s60
    s_mov_b32 s13, s61
    s_mov_b32 s14, 1605632
    s_mov_b32 s15, 0x20000
    s_mov_b32 s20, s50
    s_mov_b32 s21, s51
    s_mov_b32 s22, 921600
    s_mov_b32 s23, 0x20000
    s_mov_b32 s24, s52
    s_mov_b32 s25, s53
    s_mov_b32 s26, 921600
    s_mov_b32 s27, 0x20000
    v_mov_b32 v8, v2
    v_mov_b32 v9, v4
    s_mov_b32 s40, s47
    s_mov_b32 s41, s72
    s_mov_b32 s42, s73
    s_mov_b32 s4, s48
    s_mov_b32 s5, s49
    s_mov_b32 s6, 1835008
    s_mov_b32 s7, 0x20000
    s_mov_b32 s32, s64
    s_mov_b32 s33, s65
    s_mov_b32 s34, 896
    s_mov_b32 s35, 0x20000
    s_mov_b32 s16, s70
    s_mov_b32 s17, s71
    s_mov_b32 s18, 16252928
    s_mov_b32 s19, 0x20000
    buffer_load_dword v24, off, s[16:19], 0 sc1
    s_lshr_b32 s47, s46, 3
    s_lshl_b32 s77, s45, 2
    s_add_u32 s47, s47, s77
    s_lshl_b32 s47, s47, 1
    s_add_u32 s47, s47, s44
    s_and_b32 s77, s79, 1
    s_lshl_b32 s77, s77, 10
    s_bfe_u32 s78, s79, 0x10001
    s_lshl_b32 s78, s78, 6
    s_add_u32 s77, s77, s78
    s_lshr_b32 s78, s79, 2
    s_add_u32 s77, s77, s78
    s_lshl_b32 s78, s47, 1
    s_add_u32 s77, s77, s78
    s_mul_i32 s72, s77, 896
    v_lshrrev_b32 v2, 3, v1
    v_and_b32 v3, 7, v1
    v_lshlrev_b32 v3, 4, v3
    s_mov_b32 s77, 114688
    v_mad_u32_u24 v4, v2, s77, v3
    buffer_load_dwordx4 v[32:35], v4, s[4:7], s72 offen offset:0
    buffer_load_dwordx4 v[64:67], v3, s[32:35], 0 offen offset:0
    buffer_load_dwordx4 v[36:39], v4, s[4:7], s72 offen offset:128
    buffer_load_dwordx4 v[68:71], v3, s[32:35], 0 offen offset:128
    buffer_load_dwordx4 v[40:43], v4, s[4:7], s72 offen offset:256
    buffer_load_dwordx4 v[72:75], v3, s[32:35], 0 offen offset:256
    buffer_load_dwordx4 v[44:47], v4, s[4:7], s72 offen offset:384
    buffer_load_dwordx4 v[76:79], v3, s[32:35], 0 offen offset:384
    buffer_load_dwordx4 v[48:51], v4, s[4:7], s72 offen offset:512
    buffer_load_dwordx4 v[80:83], v3, s[32:35], 0 offen offset:512
    buffer_load_dwordx4 v[52:55], v4, s[4:7], s72 offen offset:640
    buffer_load_dwordx4 v[84:87], v3, s[32:35], 0 offen offset:640
    buffer_load_dwordx4 v[56:59], v4, s[4:7], s72 offen offset:768
    buffer_load_dwordx4 v[88:91], v3, s[32:35], 0 offen offset:768
    s_and_b32 s77, s2, 3
    s_lshl_b32 s36, s77, 5
    s_add_u32 s36, s36, s46
    s_lshr_b32 s77, s36, 3
    s_bfe_u32 s78, s36, 0x20001
    s_lshl_b32 s78, s78, 4
    s_add_u32 s77, s77, s78
    s_and_b32 s78, s36, 1
    s_lshl_b32 s78, s78, 10
    s_add_u32 s77, s77, s78
    v_lshrrev_b32 v26, 2, v1
    v_lshl_add_u32 v27, v26, 6, s77
    v_sub_u32 v28, 2048, v27
    v_and_b32 v28, 2047, v28
    v_and_b32 v29, 1, v1
    v_cmp_eq_u32 vcc, 1, v29
    v_bfe_u32 v29, v1, 1, 1
    v_mul_u32_u24 v29, 448, v29
    v_cndmask_b32 v27, v27, v28, vcc
    s_movk_i32 s77, 450
    v_mad_u32_u24 v27, v27, s77, v29
    s_bitcmp1_b32 s2, 2
    s_cselect_b32 s37, 0x40000000, 0
    buffer_load_ushort v22, v27, s[20:23], s37 offen
    buffer_load_ushort v23, v27, s[24:27], s37 offen
    v_mov_b32 v20, 0
    v_mov_b32 v21, 0
    s_waitcnt vmcnt(16)
    v_readfirstlane_b32 s77, v24
    s_nop 0
    s_add_u32 s75, s77, 1
    s_mul_i32 s77, s77, 0x9E3779B1
    s_add_u32 s73, s77, 0x7F4A7C15
    s_add_u32 s74, s73, 1
    v_mov_b32 v24, s73
    s_waitcnt vmcnt(1)
    v_lshlrev_b32 v22, 16, v22
    s_waitcnt vmcnt(0)
    v_lshlrev_b32 v23, 16, v23
    v_add_f32_dpp v28, v22, v22 quad_perm:[1,0,3,2] row_mask:0xf bank_mask:0xf
    s_nop 0
    v_subrev_f32_dpp v29, v23, v23 quad_perm:[1,0,3,2] row_mask:0xf bank_mask:0xf
    v_cvt_pk_bf16_f32 v28, v28, v29
    v_mov_b32 v30, v24
    v_mov_b32 v31, v24
    v_mov_b32_dpp v29, v28 quad_perm:[2,2,2,2] row_mask:0xf bank_mask:0xf
    v_lshlrev_b32 v26, 4, v26
    s_lshl_b32 s77, s36, 8
    s_add_u32 s77, s77, 262144
    s_add_u32 s77, s77, s37
    s_mov_b32 exec_lo, 0x11111111
    s_mov_b32 exec_hi, 0x11111111
    buffer_store_dwordx4 v[28:31], v26, s[16:19], s77 offen sc1
    s_mov_b64 exec, -1
    v_dot2c_f32_bf16 v20, v32, v64
    v_dot2c_f32_bf16 v21, v33, v65
    v_dot2c_f32_bf16 v20, v34, v66
    v_dot2c_f32_bf16 v21, v35, v67
    v_dot2c_f32_bf16 v20, v36, v68
    v_dot2c_f32_bf16 v21, v37, v69
    v_dot2c_f32_bf16 v20, v38, v70
    v_dot2c_f32_bf16 v21, v39, v71
    v_dot2c_f32_bf16 v20, v40, v72
    v_dot2c_f32_bf16 v21, v41, v73
    v_dot2c_f32_bf16 v20, v42, v74
    v_dot2c_f32_bf16 v21, v43, v75
    v_dot2c_f32_bf16 v20, v44, v76
    v_dot2c_f32_bf16 v21, v45, v77
    v_dot2c_f32_bf16 v20, v46, v78
    v_dot2c_f32_bf16 v21, v47, v79
    v_dot2c_f32_bf16 v20, v48, v80
    v_dot2c_f32_bf16 v21, v49, v81
    v_dot2c_f32_bf16 v20, v50, v82
    v_dot2c_f32_bf16 v21, v51, v83
    v_dot2c_f32_bf16 v20, v52, v84
    v_dot2c_f32_bf16 v21, v53, v85
    v_dot2c_f32_bf16 v20, v54, v86
    v_dot2c_f32_bf16 v21, v55, v87
    v_dot2c_f32_bf16 v20, v56, v88
    v_dot2c_f32_bf16 v21, v57, v89
    v_dot2c_f32_bf16 v20, v58, v90
    v_dot2c_f32_bf16 v21, v59, v91
    s_nop 2
    v_add_f32 v20, v20, v21
    s_nop 1
    v_add_f32_dpp v20, v20, v20 quad_perm:[1,0,3,2] row_mask:0xf bank_mask:0xf
    s_nop 1
    v_add_f32_dpp v20, v20, v20 quad_perm:[2,3,0,1] row_mask:0xf bank_mask:0xf
    s_nop 1
    v_add_f32_dpp v20, v20, v20 row_half_mirror row_mask:0xf bank_mask:0xf
    v_mul_f32 v20, 0xbfb8aa3b, v20
    v_exp_f32 v20, v20
    s_nop 0
    v_add_f32 v20, 1.0, v20
    v_rcp_f32 v20, v20
    v_mov_b32 v21, v24
    s_lshl_b32 s77, s47, 9
    s_lshl_b32 s78, s79, 6
    s_add_u32 s77, s77, s78
    s_add_u32 s77, s77, 32768
    v_lshlrev_b32 v2, 3, v2
    s_mov_b32 exec_lo, 0x01010101
    s_mov_b32 exec_hi, 0x01010101
    buffer_store_dwordx2 v[20:21], v2, s[16:19], s77 offen sc1
    s_mov_b64 exec, -1
    s_barrier
L_end:
    s_endpgm
.section .rodata,"a"
.p2align 6
.amdhsa_kernel gated_mix__spectral_gfnet__dense_activation_gelu__prompt_kernel
  .amdhsa_next_free_vgpr 256
  .amdhsa_next_free_sgpr 102
  .amdhsa_accum_offset 144
  .amdhsa_group_segment_fixed_size 0
  .amdhsa_kernarg_size 96
  .amdhsa_user_sgpr_count 2
  .amdhsa_user_sgpr_kernarg_segment_ptr 1
  .amdhsa_system_sgpr_workgroup_id_x 1
.end_amdhsa_kernel
```
